```python
import torch

def _softmax(x, axis=-1):
    return torch.softmax(x, dim=axis)
def _gelu(x):
    return torch.nn.functional.gelu(x, approximate="tanh")
def _silu(x):
    return torch.nn.functional.silu(x)
def _sigmoid(x):
    return torch.sigmoid(x)
def _layernorm(x, axis=-1, eps=1e-5):
    m = x.mean(dim=axis, keepdim=True)
    v = x.var(dim=axis, keepdim=True, unbiased=False)
    return (x - m) / torch.sqrt(v + eps)
def _scatter_add(tgt, idx, src, axis=0):
    return tgt.clone().index_add_(axis, idx, src)
def _segment_sum(src, seg, n):
    out = torch.zeros((n,) + src.shape[1:], dtype=src.dtype)
    return out.index_add_(0, seg, src)
def _pad(x, pw):
    flat = tuple(v for pair in reversed(pw) for v in pair)
    return torch.nn.functional.pad(x, flat)

kernel_name = 'standalone__gqa_block_cached__decode'

def setup_inputs():

    _w = (lambda a: (lambda t: t.to(torch.bfloat16) if t.is_floating_point() else t)(torch.as_tensor(a)))
    B, Sq, D = 1, 1, 512
    Hq, Hkv, Sk, Dh = 32, 8, 65536, 128
    assert Hq % Hkv == 0, (Hq, Hkv)
    return {
        "x": _w((lambda *s: torch.randn(*s, dtype=torch.bfloat16) * 0.8)(B, Sq, D)),
        "k_cache": _w((lambda *s: torch.randn(*s, dtype=torch.bfloat16) * 0.8)(B, Hkv, Sk, Dh)),
        "v_cache": _w((lambda *s: torch.randn(*s, dtype=torch.bfloat16) * 0.05)(B, Hkv, Sk, Dh)),
        "wq": _w((lambda *s: torch.randn(*s, dtype=torch.bfloat16) * 0.8)(D, Hq * Dh) * (D ** -0.5)),
        "wo": _w((lambda *s: torch.randn(*s, dtype=torch.bfloat16) * 0.05)(Hq * Dh, D) * ((Hq * Dh) ** -0.5)),
    }

def reference(x, k_cache, v_cache, wq, wo):
    B, Sq, D = x.shape
    Hq, Dh = 32, 128
    Hkv = k_cache.shape[1]
    rep = Hq // Hkv
    q = (lambda x, *d: x.permute(*d))((x @ wq).reshape(B, Sq, Hq, Dh), 0, 2, 1, 3)
    k = (lambda x, n, axis: torch.repeat_interleave(x, n, dim=axis))(k_cache, rep, axis=1)
    v = (lambda x, n, axis: torch.repeat_interleave(x, n, dim=axis))(v_cache, rep, axis=1)
    scores = torch.einsum("bhqd,bhkd->bhqk", q, k) * (Dh ** -0.5)
    p = _softmax(scores, axis=-1)
    o = torch.einsum("bhqk,bhkd->bhqd", p, v)
    return (lambda x, *d: x.permute(*d))(o, 0, 2, 1, 3).reshape(B, Sq, Hq * Dh) @ wo
```

```asm
; @launch grid=(256,1,1) block=(320,1,1) lds=149696
.amdgcn_target "amdgcn-amd-amdhsa--gfx950"
.text
.globl standalone__gqa_block_cached__decode_kernel
.p2align 8
.type standalone__gqa_block_cached__decode_kernel,@function
standalone__gqa_block_cached__decode_kernel:
  s_cmp_ge_u32 s2, 256
  s_cbranch_scc1 L_end
  s_load_dwordx16 s[4:19], s[0:1], 0
  v_lshrrev_b32 v1, 6, v0
  v_and_b32 v0, 63, v0
  s_and_b32 s79, s2, 1
  s_and_b32 s20, s2, 6
  s_lshr_b32 s21, s2, 7
  s_add_u32 s20, s20, s21
  s_bfe_u32 s21, s2, 0x40003
  s_lshl_b32 s23, s79, 4
  s_add_u32 s21, s21, s23
  s_lshl_b32 s2, s21, 3
  s_add_u32 s2, s2, s20
  v_readfirstlane_b32 s3, v1
  s_mov_b32 s75, s2
  s_mov_b32 s27, 0x00020000
  s_mov_b32 s31, 0x00020000
  s_mov_b32 s39, 0x00020000
  s_mov_b32 s38, 5242880
  s_cmp_lg_u32 s3, 0
  s_cbranch_scc1 L_stream
  s_setprio 3
  v_lshrrev_b32 v3, 3, v0
  v_and_b32 v4, 7, v0
  v_lshlrev_b32 v1, 5, v3
  v_lshlrev_b32 v2, 17, v3
  v_lshl_add_u32 v2, v4, 4, v2
  s_add_u32 s56, s21, 0
  s_and_b32 s56, s56, 7
  s_lshr_b32 s57, s21, 3
  s_lshl_b32 s22, s20, 10
  s_mul_i32 s23, s56, 128
  s_add_u32 s22, s22, s23
  s_mul_i32 s23, s57, 1048576
  s_add_u32 s22, s22, s23
  s_sub_u32 s30, 0x400000, s22
  s_mov_b32 s26, 1024
  s_mul_i32 s58, s57, 256
  s_mov_b32 s59, 8192
  s_waitcnt lgkmcnt(0)
  s_mov_b32 s24, s4
  s_mov_b32 s25, s5
  s_add_u32 s28, s10, s22
  s_addc_u32 s29, s11, 0
  s_load_dword s40, s[18:19], 0
  buffer_load_dwordx4 v[24:27], v1, s[24:27], s58 offen
  buffer_load_dwordx4 v[28:31], v1, s[24:27], s58 offen offset:16
  buffer_load_dwordx4 v[40:43], v2, s[28:31], 0 offen nt
  buffer_load_dwordx4 v[44:47], v2, s[28:31], s59 offen nt
  s_add_u32 s59, s59, 8192
  buffer_load_dwordx4 v[48:51], v2, s[28:31], s59 offen nt
  s_add_u32 s59, s59, 8192
  buffer_load_dwordx4 v[52:55], v2, s[28:31], s59 offen nt
  s_add_u32 s59, s59, 8192
  buffer_load_dwordx4 v[56:59], v2, s[28:31], s59 offen nt
  s_add_u32 s59, s59, 8192
  buffer_load_dwordx4 v[60:63], v2, s[28:31], s59 offen nt
  s_add_u32 s59, s59, 8192
  buffer_load_dwordx4 v[64:67], v2, s[28:31], s59 offen nt
  s_add_u32 s59, s59, 8192
  buffer_load_dwordx4 v[68:71], v2, s[28:31], s59 offen nt
  s_add_u32 s59, s59, 8192
  buffer_load_dwordx4 v[72:75], v2, s[28:31], s59 offen nt
  s_add_u32 s59, s59, 8192
  buffer_load_dwordx4 v[76:79], v2, s[28:31], s59 offen nt
  s_add_u32 s59, s59, 8192
  buffer_load_dwordx4 v[80:83], v2, s[28:31], s59 offen nt
  s_add_u32 s59, s59, 8192
  buffer_load_dwordx4 v[84:87], v2, s[28:31], s59 offen nt
  s_add_u32 s59, s59, 8192
  buffer_load_dwordx4 v[88:91], v2, s[28:31], s59 offen nt
  s_add_u32 s59, s59, 8192
  buffer_load_dwordx4 v[92:95], v2, s[28:31], s59 offen nt
  s_add_u32 s59, s59, 8192
  buffer_load_dwordx4 v[96:99], v2, s[28:31], s59 offen nt
  s_add_u32 s59, s59, 8192
  buffer_load_dwordx4 v[100:103], v2, s[28:31], s59 offen nt
  s_barrier
  s_mov_b32 s36, s18
  s_mov_b32 s37, s19
  s_mov_b32 s41, 0x05040100
  s_mov_b32 s42, 0x07060302
  s_mul_i32 s43, s20, 16384
  s_add_u32 s43, s43, 393216
  s_add_u32 s50, s43, 4096
  s_add_u32 s51, s43, 8192
  s_add_u32 s52, s43, 12288
  s_lshl_b32 s44, s57, 12
  s_add_u32 s44, s44, s43
  s_mul_i32 s23, s56, 128
  s_add_u32 s44, s44, s23
  v_lshrrev_b32 v3, 4, v0
  v_lshlrev_b32 v3, 10, v3
  v_lshl_add_u32 v3, v4, 4, v3
  v_lshlrev_b32 v32, 4, v0
  v_add_u32 v33, 148480, v32
  s_waitcnt vmcnt(12)
  v_perm_b32 v16, v44, v40, s41
  v_perm_b32 v17, v44, v40, s42
  v_dot2_f32_bf16 v8, v16, v24, 0
  v_dot2_f32_bf16 v9, v17, v24, 0
  v_perm_b32 v18, v45, v41, s41
  v_perm_b32 v19, v45, v41, s42
  v_dot2_f32_bf16 v10, v18, v24, 0
  v_dot2_f32_bf16 v11, v19, v24, 0
  v_perm_b32 v20, v46, v42, s41
  v_perm_b32 v21, v46, v42, s42
  v_dot2_f32_bf16 v12, v20, v24, 0
  v_dot2_f32_bf16 v13, v21, v24, 0
  v_perm_b32 v22, v47, v43, s41
  v_perm_b32 v23, v47, v43, s42
  v_dot2_f32_bf16 v14, v22, v24, 0
  v_dot2_f32_bf16 v15, v23, v24, 0
  v_perm_b32 v16, v52, v48, s41
  v_perm_b32 v17, v52, v48, s42
  v_dot2_f32_bf16 v8, v16, v25, v8
  v_dot2_f32_bf16 v9, v17, v25, v9
  v_perm_b32 v18, v53, v49, s41
  v_perm_b32 v19, v53, v49, s42
  v_dot2_f32_bf16 v10, v18, v25, v10
  v_dot2_f32_bf16 v11, v19, v25, v11
  v_perm_b32 v20, v54, v50, s41
  v_perm_b32 v21, v54, v50, s42
  v_dot2_f32_bf16 v12, v20, v25, v12
  v_dot2_f32_bf16 v13, v21, v25, v13
  v_perm_b32 v22, v55, v51, s41
  v_perm_b32 v23, v55, v51, s42
  v_dot2_f32_bf16 v14, v22, v25, v14
  v_dot2_f32_bf16 v15, v23, v25, v15
  s_waitcnt vmcnt(8)
  v_perm_b32 v16, v60, v56, s41
  v_perm_b32 v17, v60, v56, s42
  v_dot2_f32_bf16 v8, v16, v26, v8
  v_dot2_f32_bf16 v9, v17, v26, v9
  v_perm_b32 v18, v61, v57, s41
  v_perm_b32 v19, v61, v57, s42
  v_dot2_f32_bf16 v10, v18, v26, v10
  v_dot2_f32_bf16 v11, v19, v26, v11
  v_perm_b32 v20, v62, v58, s41
  v_perm_b32 v21, v62, v58, s42
  v_dot2_f32_bf16 v12, v20, v26, v12
  v_dot2_f32_bf16 v13, v21, v26, v13
  v_perm_b32 v22, v63, v59, s41
  v_perm_b32 v23, v63, v59, s42
  v_dot2_f32_bf16 v14, v22, v26, v14
  v_dot2_f32_bf16 v15, v23, v26, v15
  v_perm_b32 v16, v68, v64, s41
  v_perm_b32 v17, v68, v64, s42
  v_dot2_f32_bf16 v8, v16, v27, v8
  v_dot2_f32_bf16 v9, v17, v27, v9
  v_perm_b32 v18, v69, v65, s41
  v_perm_b32 v19, v69, v65, s42
  v_dot2_f32_bf16 v10, v18, v27, v10
  v_dot2_f32_bf16 v11, v19, v27, v11
  v_perm_b32 v20, v70, v66, s41
  v_perm_b32 v21, v70, v66, s42
  v_dot2_f32_bf16 v12, v20, v27, v12
  v_dot2_f32_bf16 v13, v21, v27, v13
  v_perm_b32 v22, v71, v67, s41
  v_perm_b32 v23, v71, v67, s42
  v_dot2_f32_bf16 v14, v22, v27, v14
  v_dot2_f32_bf16 v15, v23, v27, v15
  s_waitcnt vmcnt(4)
  v_perm_b32 v16, v76, v72, s41
  v_perm_b32 v17, v76, v72, s42
  v_dot2_f32_bf16 v8, v16, v28, v8
  v_dot2_f32_bf16 v9, v17, v28, v9
  v_perm_b32 v18, v77, v73, s41
  v_perm_b32 v19, v77, v73, s42
  v_dot2_f32_bf16 v10, v18, v28, v10
  v_dot2_f32_bf16 v11, v19, v28, v11
  v_perm_b32 v20, v78, v74, s41
  v_perm_b32 v21, v78, v74, s42
  v_dot2_f32_bf16 v12, v20, v28, v12
  v_dot2_f32_bf16 v13, v21, v28, v13
  v_perm_b32 v22, v79, v75, s41
  v_perm_b32 v23, v79, v75, s42
  v_dot2_f32_bf16 v14, v22, v28, v14
  v_dot2_f32_bf16 v15, v23, v28, v15
  v_perm_b32 v16, v84, v80, s41
  v_perm_b32 v17, v84, v80, s42
  v_dot2_f32_bf16 v8, v16, v29, v8
  v_dot2_f32_bf16 v9, v17, v29, v9
  v_perm_b32 v18, v85, v81, s41
  v_perm_b32 v19, v85, v81, s42
  v_dot2_f32_bf16 v10, v18, v29, v10
  v_dot2_f32_bf16 v11, v19, v29, v11
  v_perm_b32 v20, v86, v82, s41
  v_perm_b32 v21, v86, v82, s42
  v_dot2_f32_bf16 v12, v20, v29, v12
  v_dot2_f32_bf16 v13, v21, v29, v13
  v_perm_b32 v22, v87, v83, s41
  v_perm_b32 v23, v87, v83, s42
  v_dot2_f32_bf16 v14, v22, v29, v14
  v_dot2_f32_bf16 v15, v23, v29, v15
  s_waitcnt vmcnt(0)
  v_perm_b32 v16, v92, v88, s41
  v_perm_b32 v17, v92, v88, s42
  v_dot2_f32_bf16 v8, v16, v30, v8
  v_dot2_f32_bf16 v9, v17, v30, v9
  v_perm_b32 v18, v93, v89, s41
  v_perm_b32 v19, v93, v89, s42
  v_dot2_f32_bf16 v10, v18, v30, v10
  v_dot2_f32_bf16 v11, v19, v30, v11
  v_perm_b32 v20, v94, v90, s41
  v_perm_b32 v21, v94, v90, s42
  v_dot2_f32_bf16 v12, v20, v30, v12
  v_dot2_f32_bf16 v13, v21, v30, v13
  v_perm_b32 v22, v95, v91, s41
  v_perm_b32 v23, v95, v91, s42
  v_dot2_f32_bf16 v14, v22, v30, v14
  v_dot2_f32_bf16 v15, v23, v30, v15
  v_perm_b32 v16, v100, v96, s41
  v_perm_b32 v17, v100, v96, s42
  v_dot2_f32_bf16 v8, v16, v31, v8
  v_dot2_f32_bf16 v9, v17, v31, v9
  v_perm_b32 v18, v101, v97, s41
  v_perm_b32 v19, v101, v97, s42
  v_dot2_f32_bf16 v10, v18, v31, v10
  v_dot2_f32_bf16 v11, v19, v31, v11
  v_perm_b32 v20, v102, v98, s41
  v_perm_b32 v21, v102, v98, s42
  v_dot2_f32_bf16 v12, v20, v31, v12
  v_dot2_f32_bf16 v13, v21, v31, v13
  v_perm_b32 v22, v103, v99, s41
  v_perm_b32 v23, v103, v99, s42
  v_dot2_f32_bf16 v14, v22, v31, v14
  v_dot2_f32_bf16 v15, v23, v31, v15
  s_waitcnt lgkmcnt(0)
  s_mul_i32 s40, s40, 0x41c64e6d
  s_add_u32 s40, s40, 0x3039
  v_mov_b32 v17, s40
  v_permlane32_swap_b32 v8, v12
  v_permlane32_swap_b32 v9, v13
  v_permlane32_swap_b32 v10, v14
  v_permlane32_swap_b32 v11, v15
  v_mov_b32 v19, s40
  v_add_f32 v8, v8, v12
  v_add_f32 v9, v9, v13
  v_add_f32 v10, v10, v14
  v_add_f32 v11, v11, v15
  s_nop 1
  v_permlane16_swap_b32 v8, v10
  v_permlane16_swap_b32 v9, v11
  s_mov_b32 s46, 0xff00ff
  v_add_f32 v8, v8, v10
  v_add_f32 v9, v9, v11
  s_mov_b32 s47, 0xff00ff
  s_nop 0
  v_add_f32_dpp v16, v8, v8 row_ror:8 row_mask:0xf bank_mask:0xf
  v_add_f32_dpp v18, v9, v9 row_ror:8 row_mask:0xf bank_mask:0xf
  s_mov_b64 exec, s[46:47]
  buffer_store_dwordx4 v[16:19], v3, s[36:39], s44 offen sc1
  s_mov_b64 exec, -1
  s_mov_b32 s48, 20000
  s_barrier
  buffer_load_dwordx4 v[40:43], v32, s[36:39], s43 offen offset:0
  buffer_load_dwordx4 v[44:47], v32, s[36:39], s43 offen offset:1024
  buffer_load_dwordx4 v[48:51], v32, s[36:39], s43 offen offset:2048
  buffer_load_dwordx4 v[52:55], v32, s[36:39], s43 offen offset:3072
  buffer_load_dwordx4 v[56:59], v32, s[36:39], s50 offen offset:0
  buffer_load_dwordx4 v[60:63], v32, s[36:39], s50 offen offset:1024
  buffer_load_dwordx4 v[64:67], v32, s[36:39], s50 offen offset:2048
  buffer_load_dwordx4 v[68:71], v32, s[36:39], s50 offen offset:3072
  buffer_load_dwordx4 v[72:75], v32, s[36:39], s51 offen offset:0
  buffer_load_dwordx4 v[76:79], v32, s[36:39], s51 offen offset:1024
  buffer_load_dwordx4 v[80:83], v32, s[36:39], s51 offen offset:2048
  buffer_load_dwordx4 v[84:87], v32, s[36:39], s51 offen offset:3072
  buffer_load_dwordx4 v[88:91], v32, s[36:39], s52 offen offset:0
  buffer_load_dwordx4 v[92:95], v32, s[36:39], s52 offen offset:1024
  buffer_load_dwordx4 v[96:99], v32, s[36:39], s52 offen offset:2048
  buffer_load_dwordx4 v[100:103], v32, s[36:39], s52 offen offset:3072
  s_branch L_qchk
L_qpoll:
  buffer_load_dwordx4 v[40:43], v32, s[36:39], s43 offen offset:0 sc1
  buffer_load_dwordx4 v[44:47], v32, s[36:39], s43 offen offset:1024 sc1
  buffer_load_dwordx4 v[48:51], v32, s[36:39], s43 offen offset:2048 sc1
  buffer_load_dwordx4 v[52:55], v32, s[36:39], s43 offen offset:3072 sc1
  buffer_load_dwordx4 v[56:59], v32, s[36:39], s50 offen offset:0 sc1
  buffer_load_dwordx4 v[60:63], v32, s[36:39], s50 offen offset:1024 sc1
  buffer_load_dwordx4 v[64:67], v32, s[36:39], s50 offen offset:2048 sc1
  buffer_load_dwordx4 v[68:71], v32, s[36:39], s50 offen offset:3072 sc1
  buffer_load_dwordx4 v[72:75], v32, s[36:39], s51 offen offset:0 sc1
  buffer_load_dwordx4 v[76:79], v32, s[36:39], s51 offen offset:1024 sc1
  buffer_load_dwordx4 v[80:83], v32, s[36:39], s51 offen offset:2048 sc1
  buffer_load_dwordx4 v[84:87], v32, s[36:39], s51 offen offset:3072 sc1
  buffer_load_dwordx4 v[88:91], v32, s[36:39], s52 offen offset:0 sc1
  buffer_load_dwordx4 v[92:95], v32, s[36:39], s52 offen offset:1024 sc1
  buffer_load_dwordx4 v[96:99], v32, s[36:39], s52 offen offset:2048 sc1
  buffer_load_dwordx4 v[100:103], v32, s[36:39], s52 offen offset:3072 sc1
L_qchk:
  s_waitcnt vmcnt(0)
  v_min3_u32 v24, v41, v43, v19
  v_max3_u32 v25, v41, v43, v19
  v_min3_u32 v24, v24, v45, v47
  v_max3_u32 v25, v25, v45, v47
  v_min3_u32 v24, v24, v49, v51
  v_max3_u32 v25, v25, v49, v51
  v_min3_u32 v24, v24, v53, v55
  v_max3_u32 v25, v25, v53, v55
  v_min3_u32 v24, v24, v57, v59
  v_max3_u32 v25, v25, v57, v59
  v_min3_u32 v24, v24, v61, v63
  v_max3_u32 v25, v25, v61, v63
  v_min3_u32 v24, v24, v65, v67
  v_max3_u32 v25, v25, v65, v67
  v_min3_u32 v24, v24, v69, v71
  v_max3_u32 v25, v25, v69, v71
  v_min3_u32 v24, v24, v73, v75
  v_max3_u32 v25, v25, v73, v75
  v_min3_u32 v24, v24, v77, v79
  v_max3_u32 v25, v25, v77, v79
  v_min3_u32 v24, v24, v81, v83
  v_max3_u32 v25, v25, v81, v83
  v_min3_u32 v24, v24, v85, v87
  v_max3_u32 v25, v25, v85, v87
  v_min3_u32 v24, v24, v89, v91
  v_max3_u32 v25, v25, v89, v91
  v_min3_u32 v24, v24, v93, v95
  v_max3_u32 v25, v25, v93, v95
  v_min3_u32 v24, v24, v97, v99
  v_max3_u32 v25, v25, v97, v99
  v_min3_u32 v24, v24, v101, v103
  v_max3_u32 v25, v25, v101, v103
  v_cmp_ne_u32 vcc, v24, v25
  s_sub_u32 s48, s48, 1
  s_cmp_eq_u64 vcc, 0
  s_cbranch_scc1 L_qdone
  s_cmp_eq_u32 s48, 0
  s_cbranch_scc1 L_qdone
  s_sleep 15
  s_branch L_qpoll
L_qdone:
  v_add_f32 v40, v40, v56
  v_add_f32 v42, v42, v58
  v_add_f32 v44, v44, v60
  v_add_f32 v46, v46, v62
  v_add_f32 v48, v48, v64
  v_add_f32 v50, v50, v66
  v_add_f32 v52, v52, v68
  v_add_f32 v54, v54, v70
  v_add_f32 v40, v40, v72
  v_add_f32 v42, v42, v74
  v_add_f32 v44, v44, v76
  v_add_f32 v46, v46, v78
  v_add_f32 v48, v48, v80
  v_add_f32 v50, v50, v82
  v_add_f32 v52, v52, v84
  v_add_f32 v54, v54, v86
  v_add_f32 v40, v40, v88
  v_add_f32 v42, v42, v90
  v_add_f32 v44, v44, v92
  v_add_f32 v46, v46, v94
  v_add_f32 v48, v48, v96
  v_add_f32 v50, v50, v98
  v_add_f32 v52, v52, v100
  v_add_f32 v54, v54, v102
  v_cvt_pk_bf16_f32 v8, v40, v42
  v_cvt_pk_bf16_f32 v9, v44, v46
  v_cvt_pk_bf16_f32 v10, v48, v50
  v_cvt_pk_bf16_f32 v11, v52, v54
  v_mov_b32 v34, 149504
  ds_write_b128 v33, v[8:11]
  ds_write_b32 v34, v19
  s_waitcnt lgkmcnt(0)
  s_barrier
  s_endpgm
L_stream:
  s_sub_u32 s22, s3, 1
  v_lshrrev_b32 v3, 4, v0
  v_and_b32 v2, 15, v0
  v_lshlrev_b32 v6, 4, v0
  s_lshl_b32 s46, s21, 2
  s_add_u32 s46, s46, s22
  s_and_b32 s47, s46, 15
  s_lshr_b32 s46, s46, 4
  s_lshl_b32 s46, s46, 7
  s_add_u32 s46, s46, s47
  s_lshl_b32 s46, s46, 12
  s_lshl_b32 s23, s20, 24
  s_mov_b32 s26, 0x1000000
  s_mov_b32 s30, 0x1000000
  s_mov_b32 s81, 0
  s_and_b32 s82, s81, 7
  s_lshl_b32 s82, s82, 16
  s_lshr_b32 s44, s81, 3
  s_lshl_b32 s44, s44, 22
  s_add_u32 s44, s44, s82
  s_add_u32 s44, s44, s46
  s_mul_i32 s84, s22, 28672
  s_waitcnt lgkmcnt(0)
  s_add_u32 s24, s6, s23
  s_addc_u32 s25, s7, 0
  s_add_u32 s28, s8, s23
  s_addc_u32 s29, s9, 0
  s_barrier
  buffer_load_dwordx4 v[80:83], v6, s[28:31], s44 offen offset:0 nt
  buffer_load_dwordx4 v[84:87], v6, s[28:31], s44 offen offset:1024 nt
  buffer_load_dwordx4 v[88:91], v6, s[28:31], s44 offen offset:2048 nt
  buffer_load_dwordx4 v[92:95], v6, s[28:31], s44 offen offset:3072 nt
  s_add_u32 s81, s81, 1
  s_and_b32 s82, s81, 7
  s_lshl_b32 s82, s82, 16
  s_lshr_b32 s44, s81, 3
  s_lshl_b32 s44, s44, 22
  s_add_u32 s44, s44, s82
  s_add_u32 s44, s44, s46
  buffer_load_dwordx4 v[96:99], v6, s[28:31], s44 offen offset:0 nt
  buffer_load_dwordx4 v[100:103], v6, s[28:31], s44 offen offset:1024 nt
  buffer_load_dwordx4 v[104:107], v6, s[28:31], s44 offen offset:2048 nt
  buffer_load_dwordx4 v[108:111], v6, s[28:31], s44 offen offset:3072 nt
  s_add_u32 s81, s81, 1
  s_and_b32 s82, s81, 7
  s_lshl_b32 s82, s82, 16
  s_lshr_b32 s44, s81, 3
  s_lshl_b32 s44, s44, 22
  s_add_u32 s44, s44, s82
  s_add_u32 s44, s44, s46
  buffer_load_dwordx4 v[112:115], v6, s[28:31], s44 offen offset:0 nt
  buffer_load_dwordx4 v[116:119], v6, s[28:31], s44 offen offset:1024 nt
  buffer_load_dwordx4 v[120:123], v6, s[28:31], s44 offen offset:2048 nt
  buffer_load_dwordx4 v[124:127], v6, s[28:31], s44 offen offset:3072 nt
  s_add_u32 s81, s81, 1
  s_and_b32 s82, s81, 7
  s_lshl_b32 s82, s82, 16
  s_lshr_b32 s44, s81, 3
  s_lshl_b32 s44, s44, 22
  s_add_u32 s44, s44, s82
  s_add_u32 s44, s44, s46
  buffer_load_dwordx4 v[128:131], v6, s[28:31], s44 offen offset:0 nt
  buffer_load_dwordx4 v[132:135], v6, s[28:31], s44 offen offset:1024 nt
  buffer_load_dwordx4 v[136:139], v6, s[28:31], s44 offen offset:2048 nt
  buffer_load_dwordx4 v[140:143], v6, s[28:31], s44 offen offset:3072 nt
  s_add_u32 s81, s81, 1
  s_and_b32 s82, s81, 7
  s_lshl_b32 s82, s82, 16
  s_lshr_b32 s44, s81, 3
  s_lshl_b32 s44, s44, 22
  s_add_u32 s44, s44, s82
  s_add_u32 s44, s44, s46
  buffer_load_dwordx4 v[144:147], v6, s[28:31], s44 offen offset:0 nt
  buffer_load_dwordx4 v[148:151], v6, s[28:31], s44 offen offset:1024 nt
  buffer_load_dwordx4 v[152:155], v6, s[28:31], s44 offen offset:2048 nt
  buffer_load_dwordx4 v[156:159], v6, s[28:31], s44 offen offset:3072 nt
  s_add_u32 s81, s81, 1
  s_and_b32 s82, s81, 7
  s_lshl_b32 s82, s82, 16
  s_lshr_b32 s44, s81, 3
  s_lshl_b32 s44, s44, 22
  s_add_u32 s44, s44, s82
  s_add_u32 s44, s44, s46
  buffer_load_dwordx4 v[160:163], v6, s[28:31], s44 offen offset:0 nt
  buffer_load_dwordx4 v[164:167], v6, s[28:31], s44 offen offset:1024 nt
  buffer_load_dwordx4 v[168:171], v6, s[28:31], s44 offen offset:2048 nt
  buffer_load_dwordx4 v[172:175], v6, s[28:31], s44 offen offset:3072 nt
  s_add_u32 s81, s81, 1
  s_and_b32 s82, s81, 7
  s_lshl_b32 s82, s82, 16
  s_lshr_b32 s44, s81, 3
  s_lshl_b32 s44, s44, 22
  s_add_u32 s44, s44, s82
  s_add_u32 s44, s44, s46
  s_waitcnt vmcnt(20)
  buffer_load_dwordx4 v[176:179], v6, s[28:31], s44 offen offset:0 nt
  buffer_load_dwordx4 v[180:183], v6, s[28:31], s44 offen offset:1024 nt
  buffer_load_dwordx4 v[184:187], v6, s[28:31], s44 offen offset:2048 nt
  buffer_load_dwordx4 v[188:191], v6, s[28:31], s44 offen offset:3072 nt
  s_add_u32 s81, s81, 1
  s_and_b32 s82, s81, 7
  s_lshl_b32 s82, s82, 16
  s_lshr_b32 s44, s81, 3
  s_lshl_b32 s44, s44, 22
  s_add_u32 s44, s44, s82
  s_add_u32 s44, s44, s46
  s_waitcnt vmcnt(20)
  buffer_load_dwordx4 v[192:195], v6, s[28:31], s44 offen offset:0 nt
  buffer_load_dwordx4 v[196:199], v6, s[28:31], s44 offen offset:1024 nt
  buffer_load_dwordx4 v[200:203], v6, s[28:31], s44 offen offset:2048 nt
  buffer_load_dwordx4 v[204:207], v6, s[28:31], s44 offen offset:3072 nt
  s_add_u32 s81, s81, 1
  s_and_b32 s82, s81, 7
  s_lshl_b32 s82, s82, 16
  s_lshr_b32 s44, s81, 3
  s_lshl_b32 s44, s44, 22
  s_add_u32 s44, s44, s82
  s_add_u32 s44, s44, s46
  s_mov_b32 s45, s81
  s_mov_b32 s81, 0
  s_and_b32 s82, s81, 7
  s_lshl_b32 s82, s82, 16
  s_lshr_b32 s44, s81, 3
  s_lshl_b32 s44, s44, 22
  s_add_u32 s44, s44, s82
  s_add_u32 s44, s44, s46
  s_add_u32 m0, s84, 0
  s_waitcnt vmcnt(20)
  buffer_load_dwordx4 v6, s[24:27], s44 offen offset:0 nt lds
  buffer_load_dwordx4 v6, s[24:27], s44 offen offset:1024 nt lds
  buffer_load_dwordx4 v6, s[24:27], s44 offen offset:2048 nt lds
  buffer_load_dwordx4 v6, s[24:27], s44 offen offset:3072 nt lds
  s_add_u32 s81, s81, 1
  s_and_b32 s82, s81, 7
  s_lshl_b32 s82, s82, 16
  s_lshr_b32 s44, s81, 3
  s_lshl_b32 s44, s44, 22
  s_add_u32 s44, s44, s82
  s_add_u32 s44, s44, s46
  s_add_u32 m0, s84, 4096
  s_waitcnt vmcnt(20)
  buffer_load_dwordx4 v6, s[24:27], s44 offen offset:0 nt lds
  buffer_load_dwordx4 v6, s[24:27], s44 offen offset:1024 nt lds
  buffer_load_dwordx4 v6, s[24:27], s44 offen offset:2048 nt lds
  buffer_load_dwordx4 v6, s[24:27], s44 offen offset:3072 nt lds
  s_add_u32 s81, s81, 1
  s_and_b32 s82, s81, 7
  s_lshl_b32 s82, s82, 16
  s_lshr_b32 s44, s81, 3
  s_lshl_b32 s44, s44, 22
  s_add_u32 s44, s44, s82
  s_add_u32 s44, s44, s46
  s_barrier
  s_add_u32 m0, s84, 8192
  s_waitcnt vmcnt(20)
  buffer_load_dwordx4 v6, s[24:27], s44 offen offset:0 nt lds
  buffer_load_dwordx4 v6, s[24:27], s44 offen offset:1024 nt lds
  buffer_load_dwordx4 v6, s[24:27], s44 offen offset:2048 nt lds
  buffer_load_dwordx4 v6, s[24:27], s44 offen offset:3072 nt lds
  s_add_u32 s81, s81, 1
  s_and_b32 s82, s81, 7
  s_lshl_b32 s82, s82, 16
  s_lshr_b32 s44, s81, 3
  s_lshl_b32 s44, s44, 22
  s_add_u32 s44, s44, s82
  s_add_u32 s44, s44, s46
  s_add_u32 m0, s84, 12288
  s_waitcnt vmcnt(20)
  buffer_load_dwordx4 v6, s[24:27], s44 offen offset:0 nt lds
  buffer_load_dwordx4 v6, s[24:27], s44 offen offset:1024 nt lds
  buffer_load_dwordx4 v6, s[24:27], s44 offen offset:2048 nt lds
  buffer_load_dwordx4 v6, s[24:27], s44 offen offset:3072 nt lds
  s_add_u32 s81, s81, 1
  s_and_b32 s82, s81, 7
  s_lshl_b32 s82, s82, 16
  s_lshr_b32 s44, s81, 3
  s_lshl_b32 s44, s44, 22
  s_add_u32 s44, s44, s82
  s_add_u32 s44, s44, s46
  s_add_u32 m0, s84, 16384
  s_waitcnt vmcnt(20)
  buffer_load_dwordx4 v6, s[24:27], s44 offen offset:0 nt lds
  buffer_load_dwordx4 v6, s[24:27], s44 offen offset:1024 nt lds
  buffer_load_dwordx4 v6, s[24:27], s44 offen offset:2048 nt lds
  buffer_load_dwordx4 v6, s[24:27], s44 offen offset:3072 nt lds
  s_add_u32 s81, s81, 1
  s_and_b32 s82, s81, 7
  s_lshl_b32 s82, s82, 16
  s_lshr_b32 s44, s81, 3
  s_lshl_b32 s44, s44, 22
  s_add_u32 s44, s44, s82
  s_add_u32 s44, s44, s46
  s_add_u32 m0, s84, 20480
  s_waitcnt vmcnt(20)
  buffer_load_dwordx4 v6, s[24:27], s44 offen offset:0 nt lds
  buffer_load_dwordx4 v6, s[24:27], s44 offen offset:1024 nt lds
  buffer_load_dwordx4 v6, s[24:27], s44 offen offset:2048 nt lds
  buffer_load_dwordx4 v6, s[24:27], s44 offen offset:3072 nt lds
  s_add_u32 s81, s81, 1
  s_and_b32 s82, s81, 7
  s_lshl_b32 s82, s82, 16
  s_lshr_b32 s44, s81, 3
  s_lshl_b32 s44, s44, 22
  s_add_u32 s44, s44, s82
  s_add_u32 s44, s44, s46
  s_add_u32 m0, s84, 24576
  s_waitcnt vmcnt(20)
  buffer_load_dwordx4 v6, s[24:27], s44 offen offset:0 nt lds
  buffer_load_dwordx4 v6, s[24:27], s44 offen offset:1024 nt lds
  buffer_load_dwordx4 v6, s[24:27], s44 offen offset:2048 nt lds
  buffer_load_dwordx4 v6, s[24:27], s44 offen offset:3072 nt lds
  s_add_u32 s81, s81, 1
  s_and_b32 s82, s81, 7
  s_lshl_b32 s82, s82, 16
  s_lshr_b32 s44, s81, 3
  s_lshl_b32 s44, s44, 22
  s_add_u32 s44, s44, s82
  s_add_u32 s44, s44, s46
  s_xor_b32 s78, s21, 16
  s_lshl_b32 s80, s78, 2
  s_add_u32 s80, s80, s22
  s_and_b32 s47, s80, 15
  s_lshr_b32 s80, s80, 4
  s_lshl_b32 s80, s80, 7
  s_add_u32 s80, s80, s47
  s_lshl_b32 s80, s80, 12
  s_add_u32 s80, s80, 13041664
  s_cmp_eq_u32 s79, 0
  s_cselect_b32 s78, 33, 31
  s_sub_u32 s77, s78, 5
  s_sub_u32 s76, s78, 10
  v_bfe_u32 v1, v0, 2, 2
  v_and_b32 v4, 3, v0
  s_mov_b32 s36, s18
  s_mov_b32 s37, s19
  s_mov_b32 s48, 0x3e0293ee
  s_lshr_b32 s49, s21, 2
  s_lshl_b32 s50, s20, 3
  s_add_u32 s50, s50, s49
  s_and_b32 s51, s21, 3
  s_lshl_b32 s52, s50, 16
  s_lshl_b32 s53, s51, 8
  s_add_u32 s52, s52, s53
  s_add_u32 s32, s12, s52
  s_addc_u32 s33, s13, 0
  s_mov_b32 s34, 64768
  s_mov_b32 s35, 0x00020000
  s_mul_i32 s54, s22, 8448
  s_add_u32 s54, s54, 114688
  v_lshlrev_b32 v35, 2, v0
  v_add_u32 v35, s54, v35
  v_mov_b32 v7, v35
  v_mul_u32_u24 v56, 1024, v4
  v_lshl_add_u32 v56, v1, 8, v56
  v_lshl_add_u32 v56, v3, 4, v56
  s_mov_b32 s96, 0x22222222
  s_mov_b32 s97, 0x22222222
  s_mov_b32 s98, 0x44444444
  s_mov_b32 s99, 0x44444444
  s_mov_b32 s100, 0x88888888
  s_mov_b32 s101, 0x88888888
  v_mov_b32 v36, 0xffff
  v_mov_b32 v37, 0xffff0000
  v_cndmask_b32 v33, v36, v37, s[96:97]
  v_cndmask_b32 v34, 0, v36, s[98:99]
  v_cndmask_b32 v33, v33, 0, s[98:99]
  v_cndmask_b32 v34, v34, v37, s[100:101]
  v_cndmask_b32 v33, v33, 0, s[100:101]
  v_mov_b32 v29, 0xff800000
  v_lshlrev_b32 v36, 8, v1
  v_lshl_add_u32 v36, v3, 4, v36
  v_add_u32 v36, 148480, v36
  v_mov_b32 v37, 149504
  s_mov_b32 s47, 0
  s_mov_b32 s85, s84
  s_add_u32 s86, s84, 28672
  s_barrier
  ds_read_b128 v[40:43], v36 offset:0
  ds_read_b128 v[44:47], v36 offset:64
  ds_read_b128 v[48:51], v36 offset:128
  ds_read_b128 v[52:55], v36 offset:192
  ds_read_b32 v39, v37
  v_add_u32 v60, s85, v56
  s_add_u32 s83, s84, 20480
  s_waitcnt vmcnt(24)
  ds_read_b128 v[64:67], v60 offset:0
  ds_read_b128 v[68:71], v60 offset:64
  ds_read_b128 v[72:75], v60 offset:128
  ds_read_b128 v[76:79], v60 offset:192
  s_add_u32 s47, s47, 1
  s_waitcnt lgkmcnt(3)
  v_mfma_f32_16x16x32_bf16 v[12:15], v[64:67], v[40:43], 0
  s_waitcnt lgkmcnt(2)
  v_mfma_f32_16x16x32_bf16 v[12:15], v[68:71], v[44:47], v[12:15]
  s_waitcnt lgkmcnt(1)
  v_mfma_f32_16x16x32_bf16 v[12:15], v[72:75], v[48:51], v[12:15]
  s_waitcnt lgkmcnt(0)
  v_mfma_f32_16x16x32_bf16 v[12:15], v[76:79], v[52:55], v[12:15]
  s_nop 1
  s_add_u32 s85, s85, 4096
  s_cmp_eq_u32 s85, s86
  s_cselect_b32 s85, s84, s85
  s_add_u32 s83, s83, 4096
  s_cmp_eq_u32 s83, s86
  s_cselect_b32 s83, s84, s83
  v_add_u32 v60, s85, v56
  v_cndmask_b32 v28, v12, v13, s[96:97]
  v_cndmask_b32 v28, v28, v14, s[98:99]
  v_cndmask_b32 v28, v28, v15, s[100:101]
  v_max_f32 v29, v29, v28
  ds_write_b32 v7, v28
  v_add_u32 v7, 256, v7
  s_waitcnt vmcnt(20)
  ds_read_b128 v[64:67], v60 offset:0
  ds_read_b128 v[68:71], v60 offset:64
  ds_read_b128 v[72:75], v60 offset:128
  ds_read_b128 v[76:79], v60 offset:192
  s_add_u32 s47, s47, 1
  s_waitcnt lgkmcnt(3)
  v_mfma_f32_16x16x32_bf16 v[12:15], v[64:67], v[40:43], 0
  s_waitcnt lgkmcnt(2)
  v_mfma_f32_16x16x32_bf16 v[12:15], v[68:71], v[44:47], v[12:15]
  s_waitcnt lgkmcnt(1)
  v_mfma_f32_16x16x32_bf16 v[12:15], v[72:75], v[48:51], v[12:15]
  s_waitcnt lgkmcnt(0)
  v_mfma_f32_16x16x32_bf16 v[12:15], v[76:79], v[52:55], v[12:15]
  s_nop 1
  s_add_u32 s85, s85, 4096
  s_cmp_eq_u32 s85, s86
  s_cselect_b32 s85, s84, s85
  s_add_u32 s83, s83, 4096
  s_cmp_eq_u32 s83, s86
  s_cselect_b32 s83, s84, s83
  v_add_u32 v60, s85, v56
  v_cndmask_b32 v28, v12, v13, s[96:97]
  v_cndmask_b32 v28, v28, v14, s[98:99]
  v_cndmask_b32 v28, v28, v15, s[100:101]
  v_max_f32 v29, v29, v28
  ds_write_b32 v7, v28
  v_add_u32 v7, 256, v7
L_kloop:
  s_waitcnt vmcnt(16)
  ds_read_b128 v[64:67], v60 offset:0
  ds_read_b128 v[68:71], v60 offset:64
  ds_read_b128 v[72:75], v60 offset:128
  ds_read_b128 v[76:79], v60 offset:192
  s_mov_b32 m0, s83
  s_cmp_lg_u32 s47, s77
  s_cbranch_scc1 L_knosw
  s_mov_b32 s24, s28
  s_mov_b32 s25, s29
  s_mov_b32 s81, s45
  s_and_b32 s82, s81, 7
  s_lshl_b32 s82, s82, 16
  s_lshr_b32 s44, s81, 3
  s_lshl_b32 s44, s44, 22
  s_add_u32 s44, s44, s82
  s_add_u32 s44, s44, s46
  s_cmp_ge_u32 s81, 32
  s_cselect_b32 s44, s80, s44
L_knosw:
  buffer_load_dwordx4 v6, s[24:27], s44 offen offset:0 nt lds
  buffer_load_dwordx4 v6, s[24:27], s44 offen offset:1024 nt lds
  buffer_load_dwordx4 v6, s[24:27], s44 offen offset:2048 nt lds
  buffer_load_dwordx4 v6, s[24:27], s44 offen offset:3072 nt lds
  s_add_u32 s81, s81, 1
  s_and_b32 s82, s81, 7
  s_lshl_b32 s82, s82, 16
  s_lshr_b32 s44, s81, 3
  s_lshl_b32 s44, s44, 22
  s_add_u32 s44, s44, s82
  s_add_u32 s44, s44, s46
  s_cmp_ge_u32 s81, 32
  s_cselect_b32 s44, s80, s44
  s_add_u32 s47, s47, 1
  s_waitcnt lgkmcnt(3)
  v_mfma_f32_16x16x32_bf16 v[12:15], v[64:67], v[40:43], 0
  s_waitcnt lgkmcnt(2)
  v_mfma_f32_16x16x32_bf16 v[12:15], v[68:71], v[44:47], v[12:15]
  s_waitcnt lgkmcnt(1)
  v_mfma_f32_16x16x32_bf16 v[12:15], v[72:75], v[48:51], v[12:15]
  s_waitcnt lgkmcnt(0)
  v_mfma_f32_16x16x32_bf16 v[12:15], v[76:79], v[52:55], v[12:15]
  s_nop 1
  s_add_u32 s85, s85, 4096
  s_cmp_eq_u32 s85, s86
  s_cselect_b32 s85, s84, s85
  s_add_u32 s83, s83, 4096
  s_cmp_eq_u32 s83, s86
  s_cselect_b32 s83, s84, s83
  v_add_u32 v60, s85, v56
  v_cndmask_b32 v28, v12, v13, s[96:97]
  v_cndmask_b32 v28, v28, v14, s[98:99]
  v_cndmask_b32 v28, v28, v15, s[100:101]
  s_cmp_lt_u32 s47, s78
  v_max_f32 v29, v29, v28
  ds_write_b32 v7, v28
  v_add_u32 v7, 256, v7
  s_cbranch_scc1 L_kloop
  v_mov_b32 v36, 149568
  v_max_f32_dpp v29, v29, v29 quad_perm:[1,0,3,2] row_mask:0xf bank_mask:0xf
  v_lshl_add_u32 v37, v1, 4, v36
  s_lshl_b32 s55, s22, 2
  v_max_f32_dpp v29, v29, v29 quad_perm:[2,3,0,1] row_mask:0xf bank_mask:0xf
  v_add_u32 v36, s55, v37
  v_mov_b32 v30, v29
  s_nop 1
  v_permlane16_swap_b32 v29, v30
  s_nop 0
  v_max_f32 v29, v29, v30
  v_mov_b32 v30, v29
  s_nop 1
  v_permlane32_swap_b32 v29, v30
  s_nop 0
  v_max_f32 v29, v29, v30
  ds_write_b32 v36, v29
  s_waitcnt lgkmcnt(0)
  s_barrier
  ds_read_b128 v[12:15], v37
  ds_read_b32 v28, v35
  v_mov_b32 v31, 0
  s_lshl_b32 s55, s20, 10
  s_add_u32 s55, s55, 36864
  s_lshl_b32 s56, s21, 5
  s_add_u32 s56, s56, s55
  v_lshlrev_b32 v36, 3, v1
  v_add_u32 v60, s85, v6
  s_waitcnt lgkmcnt(1)
  v_max3_f32 v38, v12, v13, v14
  v_max_f32 v38, v38, v15
  v_mov_b32 v12, 0
  v_mov_b32 v13, 0
  v_mov_b32 v14, 0
  v_mov_b32 v15, 0
  v_mov_b32 v16, 0
  v_mov_b32 v17, 0
  v_mov_b32 v18, 0
  v_mov_b32 v19, 0
  v_mul_f32 v30, s48, v38
  v_sub_f32 v30, 0, v30
  s_cmp_lg_u32 s22, 0
  s_cbranch_scc1 L_nopub
  s_mov_b64 exec, 0x1111
  buffer_store_dwordx2 v[38:39], v36, s[36:39], s56 offen sc1
  s_mov_b64 exec, -1
L_nopub:
  s_waitcnt lgkmcnt(0)
  ds_read_b32 v29, v35 offset:256
  v_fma_f32 v37, v28, s48, v30
  v_exp_f32 v37, v37
  s_nop 0
  v_cvt_pk_bf16_f32 v32, v37, v37
  v_add_f32 v31, v31, v37
  s_nop 0
  v_and_b32_dpp v20, v32, v33 quad_perm:[0,0,0,0] row_mask:0xf bank_mask:0xf
  v_and_b32_dpp v21, v32, v34 quad_perm:[0,0,0,0] row_mask:0xf bank_mask:0xf
  v_and_b32_dpp v22, v32, v33 quad_perm:[1,1,1,1] row_mask:0xf bank_mask:0xf
  v_and_b32_dpp v23, v32, v34 quad_perm:[1,1,1,1] row_mask:0xf bank_mask:0xf
  v_and_b32_dpp v24, v32, v33 quad_perm:[2,2,2,2] row_mask:0xf bank_mask:0xf
  v_and_b32_dpp v25, v32, v34 quad_perm:[2,2,2,2] row_mask:0xf bank_mask:0xf
  v_and_b32_dpp v26, v32, v33 quad_perm:[3,3,3,3] row_mask:0xf bank_mask:0xf
  v_and_b32_dpp v27, v32, v34 quad_perm:[3,3,3,3] row_mask:0xf bank_mask:0xf
  s_nop 0
  v_mfma_f32_16x16x16_bf16 v[12:15], v[80:81], v[20:21], v[12:15]
  v_mfma_f32_16x16x16_bf16 v[16:19], v[82:83], v[20:21], v[16:19]
  v_mfma_f32_16x16x16_bf16 v[12:15], v[84:85], v[22:23], v[12:15]
  v_mfma_f32_16x16x16_bf16 v[16:19], v[86:87], v[22:23], v[16:19]
  v_mfma_f32_16x16x16_bf16 v[12:15], v[88:89], v[24:25], v[12:15]
  v_mfma_f32_16x16x16_bf16 v[16:19], v[90:91], v[24:25], v[16:19]
  v_mfma_f32_16x16x16_bf16 v[12:15], v[92:93], v[26:27], v[12:15]
  v_mfma_f32_16x16x16_bf16 v[16:19], v[94:95], v[26:27], v[16:19]
  s_waitcnt lgkmcnt(0)
  ds_read_b32 v28, v35 offset:512
  v_fma_f32 v37, v29, s48, v30
  v_exp_f32 v37, v37
  s_nop 0
  v_cvt_pk_bf16_f32 v32, v37, v37
  v_add_f32 v31, v31, v37
  s_nop 0
  v_and_b32_dpp v20, v32, v33 quad_perm:[0,0,0,0] row_mask:0xf bank_mask:0xf
  v_and_b32_dpp v21, v32, v34 quad_perm:[0,0,0,0] row_mask:0xf bank_mask:0xf
  v_and_b32_dpp v22, v32, v33 quad_perm:[1,1,1,1] row_mask:0xf bank_mask:0xf
  v_and_b32_dpp v23, v32, v34 quad_perm:[1,1,1,1] row_mask:0xf bank_mask:0xf
  v_and_b32_dpp v24, v32, v33 quad_perm:[2,2,2,2] row_mask:0xf bank_mask:0xf
  v_and_b32_dpp v25, v32, v34 quad_perm:[2,2,2,2] row_mask:0xf bank_mask:0xf
  v_and_b32_dpp v26, v32, v33 quad_perm:[3,3,3,3] row_mask:0xf bank_mask:0xf
  v_and_b32_dpp v27, v32, v34 quad_perm:[3,3,3,3] row_mask:0xf bank_mask:0xf
  s_nop 0
  v_mfma_f32_16x16x16_bf16 v[12:15], v[96:97], v[20:21], v[12:15]
  v_mfma_f32_16x16x16_bf16 v[16:19], v[98:99], v[20:21], v[16:19]
  v_mfma_f32_16x16x16_bf16 v[12:15], v[100:101], v[22:23], v[12:15]
  v_mfma_f32_16x16x16_bf16 v[16:19], v[102:103], v[22:23], v[16:19]
  v_mfma_f32_16x16x16_bf16 v[12:15], v[104:105], v[24:25], v[12:15]
  v_mfma_f32_16x16x16_bf16 v[16:19], v[106:107], v[24:25], v[16:19]
  v_mfma_f32_16x16x16_bf16 v[12:15], v[108:109], v[26:27], v[12:15]
  v_mfma_f32_16x16x16_bf16 v[16:19], v[110:111], v[26:27], v[16:19]
  s_waitcnt lgkmcnt(0)
  ds_read_b32 v29, v35 offset:768
  v_fma_f32 v37, v28, s48, v30
  v_exp_f32 v37, v37
  s_nop 0
  v_cvt_pk_bf16_f32 v32, v37, v37
  v_add_f32 v31, v31, v37
  s_nop 0
  v_and_b32_dpp v20, v32, v33 quad_perm:[0,0,0,0] row_mask:0xf bank_mask:0xf
  v_and_b32_dpp v21, v32, v34 quad_perm:[0,0,0,0] row_mask:0xf bank_mask:0xf
  v_and_b32_dpp v22, v32, v33 quad_perm:[1,1,1,1] row_mask:0xf bank_mask:0xf
  v_and_b32_dpp v23, v32, v34 quad_perm:[1,1,1,1] row_mask:0xf bank_mask:0xf
  v_and_b32_dpp v24, v32, v33 quad_perm:[2,2,2,2] row_mask:0xf bank_mask:0xf
  v_and_b32_dpp v25, v32, v34 quad_perm:[2,2,2,2] row_mask:0xf bank_mask:0xf
  v_and_b32_dpp v26, v32, v33 quad_perm:[3,3,3,3] row_mask:0xf bank_mask:0xf
  v_and_b32_dpp v27, v32, v34 quad_perm:[3,3,3,3] row_mask:0xf bank_mask:0xf
  s_nop 0
  v_mfma_f32_16x16x16_bf16 v[12:15], v[112:113], v[20:21], v[12:15]
  v_mfma_f32_16x16x16_bf16 v[16:19], v[114:115], v[20:21], v[16:19]
  v_mfma_f32_16x16x16_bf16 v[12:15], v[116:117], v[22:23], v[12:15]
  v_mfma_f32_16x16x16_bf16 v[16:19], v[118:119], v[22:23], v[16:19]
  v_mfma_f32_16x16x16_bf16 v[12:15], v[120:121], v[24:25], v[12:15]
  v_mfma_f32_16x16x16_bf16 v[16:19], v[122:123], v[24:25], v[16:19]
  v_mfma_f32_16x16x16_bf16 v[12:15], v[124:125], v[26:27], v[12:15]
  v_mfma_f32_16x16x16_bf16 v[16:19], v[126:127], v[26:27], v[16:19]
  s_waitcnt lgkmcnt(0)
  ds_read_b32 v28, v35 offset:1024
  v_fma_f32 v37, v29, s48, v30
  v_exp_f32 v37, v37
  s_nop 0
  v_cvt_pk_bf16_f32 v32, v37, v37
  v_add_f32 v31, v31, v37
  s_nop 0
  v_and_b32_dpp v20, v32, v33 quad_perm:[0,0,0,0] row_mask:0xf bank_mask:0xf
  v_and_b32_dpp v21, v32, v34 quad_perm:[0,0,0,0] row_mask:0xf bank_mask:0xf
  v_and_b32_dpp v22, v32, v33 quad_perm:[1,1,1,1] row_mask:0xf bank_mask:0xf
  v_and_b32_dpp v23, v32, v34 quad_perm:[1,1,1,1] row_mask:0xf bank_mask:0xf
  v_and_b32_dpp v24, v32, v33 quad_perm:[2,2,2,2] row_mask:0xf bank_mask:0xf
  v_and_b32_dpp v25, v32, v34 quad_perm:[2,2,2,2] row_mask:0xf bank_mask:0xf
  v_and_b32_dpp v26, v32, v33 quad_perm:[3,3,3,3] row_mask:0xf bank_mask:0xf
  v_and_b32_dpp v27, v32, v34 quad_perm:[3,3,3,3] row_mask:0xf bank_mask:0xf
  s_nop 0
  v_mfma_f32_16x16x16_bf16 v[12:15], v[128:129], v[20:21], v[12:15]
  v_mfma_f32_16x16x16_bf16 v[16:19], v[130:131], v[20:21], v[16:19]
  v_mfma_f32_16x16x16_bf16 v[12:15], v[132:133], v[22:23], v[12:15]
  v_mfma_f32_16x16x16_bf16 v[16:19], v[134:135], v[22:23], v[16:19]
  v_mfma_f32_16x16x16_bf16 v[12:15], v[136:137], v[24:25], v[12:15]
  v_mfma_f32_16x16x16_bf16 v[16:19], v[138:139], v[24:25], v[16:19]
  v_mfma_f32_16x16x16_bf16 v[12:15], v[140:141], v[26:27], v[12:15]
  v_mfma_f32_16x16x16_bf16 v[16:19], v[142:143], v[26:27], v[16:19]
  s_waitcnt lgkmcnt(0)
  ds_read_b32 v29, v35 offset:1280
  v_fma_f32 v37, v28, s48, v30
  v_exp_f32 v37, v37
  s_nop 0
  v_cvt_pk_bf16_f32 v32, v37, v37
  v_add_f32 v31, v31, v37
  s_nop 0
  v_and_b32_dpp v20, v32, v33 quad_perm:[0,0,0,0] row_mask:0xf bank_mask:0xf
  v_and_b32_dpp v21, v32, v34 quad_perm:[0,0,0,0] row_mask:0xf bank_mask:0xf
  v_and_b32_dpp v22, v32, v33 quad_perm:[1,1,1,1] row_mask:0xf bank_mask:0xf
  v_and_b32_dpp v23, v32, v34 quad_perm:[1,1,1,1] row_mask:0xf bank_mask:0xf
  v_and_b32_dpp v24, v32, v33 quad_perm:[2,2,2,2] row_mask:0xf bank_mask:0xf
  v_and_b32_dpp v25, v32, v34 quad_perm:[2,2,2,2] row_mask:0xf bank_mask:0xf
  v_and_b32_dpp v26, v32, v33 quad_perm:[3,3,3,3] row_mask:0xf bank_mask:0xf
  v_and_b32_dpp v27, v32, v34 quad_perm:[3,3,3,3] row_mask:0xf bank_mask:0xf
  s_nop 0
  v_mfma_f32_16x16x16_bf16 v[12:15], v[144:145], v[20:21], v[12:15]
  v_mfma_f32_16x16x16_bf16 v[16:19], v[146:147], v[20:21], v[16:19]
  v_mfma_f32_16x16x16_bf16 v[12:15], v[148:149], v[22:23], v[12:15]
  v_mfma_f32_16x16x16_bf16 v[16:19], v[150:151], v[22:23], v[16:19]
  v_mfma_f32_16x16x16_bf16 v[12:15], v[152:153], v[24:25], v[12:15]
  v_mfma_f32_16x16x16_bf16 v[16:19], v[154:155], v[24:25], v[16:19]
  v_mfma_f32_16x16x16_bf16 v[12:15], v[156:157], v[26:27], v[12:15]
  v_mfma_f32_16x16x16_bf16 v[16:19], v[158:159], v[26:27], v[16:19]
  s_waitcnt lgkmcnt(0)
  ds_read_b32 v28, v35 offset:1536
  v_fma_f32 v37, v29, s48, v30
  v_exp_f32 v37, v37
  s_nop 0
  v_cvt_pk_bf16_f32 v32, v37, v37
  v_add_f32 v31, v31, v37
  s_nop 0
  v_and_b32_dpp v20, v32, v33 quad_perm:[0,0,0,0] row_mask:0xf bank_mask:0xf
  v_and_b32_dpp v21, v32, v34 quad_perm:[0,0,0,0] row_mask:0xf bank_mask:0xf
  v_and_b32_dpp v22, v32, v33 quad_perm:[1,1,1,1] row_mask:0xf bank_mask:0xf
  v_and_b32_dpp v23, v32, v34 quad_perm:[1,1,1,1] row_mask:0xf bank_mask:0xf
  v_and_b32_dpp v24, v32, v33 quad_perm:[2,2,2,2] row_mask:0xf bank_mask:0xf
  v_and_b32_dpp v25, v32, v34 quad_perm:[2,2,2,2] row_mask:0xf bank_mask:0xf
  v_and_b32_dpp v26, v32, v33 quad_perm:[3,3,3,3] row_mask:0xf bank_mask:0xf
  v_and_b32_dpp v27, v32, v34 quad_perm:[3,3,3,3] row_mask:0xf bank_mask:0xf
  s_nop 0
  v_mfma_f32_16x16x16_bf16 v[12:15], v[160:161], v[20:21], v[12:15]
  v_mfma_f32_16x16x16_bf16 v[16:19], v[162:163], v[20:21], v[16:19]
  v_mfma_f32_16x16x16_bf16 v[12:15], v[164:165], v[22:23], v[12:15]
  v_mfma_f32_16x16x16_bf16 v[16:19], v[166:167], v[22:23], v[16:19]
  v_mfma_f32_16x16x16_bf16 v[12:15], v[168:169], v[24:25], v[12:15]
  v_mfma_f32_16x16x16_bf16 v[16:19], v[170:171], v[24:25], v[16:19]
  v_mfma_f32_16x16x16_bf16 v[12:15], v[172:173], v[26:27], v[12:15]
  v_mfma_f32_16x16x16_bf16 v[16:19], v[174:175], v[26:27], v[16:19]
  s_waitcnt lgkmcnt(0)
  ds_read_b32 v29, v35 offset:1792
  v_fma_f32 v37, v28, s48, v30
  v_exp_f32 v37, v37
  s_nop 0
  v_cvt_pk_bf16_f32 v32, v37, v37
  v_add_f32 v31, v31, v37
  s_nop 0
  v_and_b32_dpp v20, v32, v33 quad_perm:[0,0,0,0] row_mask:0xf bank_mask:0xf
  v_and_b32_dpp v21, v32, v34 quad_perm:[0,0,0,0] row_mask:0xf bank_mask:0xf
  v_and_b32_dpp v22, v32, v33 quad_perm:[1,1,1,1] row_mask:0xf bank_mask:0xf
  v_and_b32_dpp v23, v32, v34 quad_perm:[1,1,1,1] row_mask:0xf bank_mask:0xf
  v_and_b32_dpp v24, v32, v33 quad_perm:[2,2,2,2] row_mask:0xf bank_mask:0xf
  v_and_b32_dpp v25, v32, v34 quad_perm:[2,2,2,2] row_mask:0xf bank_mask:0xf
  v_and_b32_dpp v26, v32, v33 quad_perm:[3,3,3,3] row_mask:0xf bank_mask:0xf
  v_and_b32_dpp v27, v32, v34 quad_perm:[3,3,3,3] row_mask:0xf bank_mask:0xf
  s_nop 0
  v_mfma_f32_16x16x16_bf16 v[12:15], v[176:177], v[20:21], v[12:15]
  v_mfma_f32_16x16x16_bf16 v[16:19], v[178:179], v[20:21], v[16:19]
  v_mfma_f32_16x16x16_bf16 v[12:15], v[180:181], v[22:23], v[12:15]
  v_mfma_f32_16x16x16_bf16 v[16:19], v[182:183], v[22:23], v[16:19]
  v_mfma_f32_16x16x16_bf16 v[12:15], v[184:185], v[24:25], v[12:15]
  v_mfma_f32_16x16x16_bf16 v[16:19], v[186:187], v[24:25], v[16:19]
  v_mfma_f32_16x16x16_bf16 v[12:15], v[188:189], v[26:27], v[12:15]
  v_mfma_f32_16x16x16_bf16 v[16:19], v[190:191], v[26:27], v[16:19]
  s_waitcnt lgkmcnt(0)
  v_fma_f32 v37, v29, s48, v30
  v_exp_f32 v37, v37
  s_nop 0
  v_cvt_pk_bf16_f32 v32, v37, v37
  v_add_f32 v31, v31, v37
  s_nop 0
  v_and_b32_dpp v20, v32, v33 quad_perm:[0,0,0,0] row_mask:0xf bank_mask:0xf
  v_and_b32_dpp v21, v32, v34 quad_perm:[0,0,0,0] row_mask:0xf bank_mask:0xf
  v_and_b32_dpp v22, v32, v33 quad_perm:[1,1,1,1] row_mask:0xf bank_mask:0xf
  v_and_b32_dpp v23, v32, v34 quad_perm:[1,1,1,1] row_mask:0xf bank_mask:0xf
  v_and_b32_dpp v24, v32, v33 quad_perm:[2,2,2,2] row_mask:0xf bank_mask:0xf
  v_and_b32_dpp v25, v32, v34 quad_perm:[2,2,2,2] row_mask:0xf bank_mask:0xf
  v_and_b32_dpp v26, v32, v33 quad_perm:[3,3,3,3] row_mask:0xf bank_mask:0xf
  v_and_b32_dpp v27, v32, v34 quad_perm:[3,3,3,3] row_mask:0xf bank_mask:0xf
  s_nop 0
  v_mfma_f32_16x16x16_bf16 v[12:15], v[192:193], v[20:21], v[12:15]
  v_mfma_f32_16x16x16_bf16 v[16:19], v[194:195], v[20:21], v[16:19]
  v_mfma_f32_16x16x16_bf16 v[12:15], v[196:197], v[22:23], v[12:15]
  v_mfma_f32_16x16x16_bf16 v[16:19], v[198:199], v[22:23], v[16:19]
  v_mfma_f32_16x16x16_bf16 v[12:15], v[200:201], v[24:25], v[12:15]
  v_mfma_f32_16x16x16_bf16 v[16:19], v[202:203], v[24:25], v[16:19]
  v_mfma_f32_16x16x16_bf16 v[12:15], v[204:205], v[26:27], v[12:15]
  v_mfma_f32_16x16x16_bf16 v[16:19], v[206:207], v[26:27], v[16:19]
  v_add_u32 v35, 2048, v35
  s_mov_b32 s47, 8
  v_lshlrev_b32 v36, 7, v4
  v_lshl_add_u32 v36, v3, 5, v36
  v_lshl_add_u32 v36, v1, 3, v36
L_vloop:
  s_cmp_lg_u32 s47, s76
  s_cbranch_scc1 L_nomg
  buffer_load_dwordx2 v[8:9], v36, s[36:39], s55 offen nt
  buffer_load_dwordx2 v[10:11], v36, s[36:39], s55 offen offset:512 nt
L_nomg:
  s_add_u32 s47, s47, 1
  s_waitcnt vmcnt(16)
  ds_read_b32 v28, v35
  ds_read_b128 v[64:67], v60 offset:0
  ds_read_b128 v[68:71], v60 offset:1024
  ds_read_b128 v[72:75], v60 offset:2048
  ds_read_b128 v[76:79], v60 offset:3072
  s_mov_b32 m0, s83
  v_add_u32 v35, 256, v35
  buffer_load_dwordx4 v6, s[24:27], s44 offen offset:0 nt lds
  buffer_load_dwordx4 v6, s[24:27], s44 offen offset:1024 nt lds
  buffer_load_dwordx4 v6, s[24:27], s44 offen offset:2048 nt lds
  buffer_load_dwordx4 v6, s[24:27], s44 offen offset:3072 nt lds
  s_add_u32 s81, s81, 1
  s_and_b32 s82, s81, 7
  s_lshl_b32 s82, s82, 16
  s_lshr_b32 s44, s81, 3
  s_lshl_b32 s44, s44, 22
  s_add_u32 s44, s44, s82
  s_add_u32 s44, s44, s46
  s_cmp_ge_u32 s81, 32
  s_cselect_b32 s44, s80, s44
  s_waitcnt lgkmcnt(4)
  v_fma_f32 v37, v28, s48, v30
  v_exp_f32 v37, v37
  s_nop 0
  v_cvt_pk_bf16_f32 v32, v37, v37
  v_add_f32 v31, v31, v37
  s_nop 0
  v_and_b32_dpp v20, v32, v33 quad_perm:[0,0,0,0] row_mask:0xf bank_mask:0xf
  v_and_b32_dpp v21, v32, v34 quad_perm:[0,0,0,0] row_mask:0xf bank_mask:0xf
  v_and_b32_dpp v22, v32, v33 quad_perm:[1,1,1,1] row_mask:0xf bank_mask:0xf
  v_and_b32_dpp v23, v32, v34 quad_perm:[1,1,1,1] row_mask:0xf bank_mask:0xf
  v_and_b32_dpp v24, v32, v33 quad_perm:[2,2,2,2] row_mask:0xf bank_mask:0xf
  v_and_b32_dpp v25, v32, v34 quad_perm:[2,2,2,2] row_mask:0xf bank_mask:0xf
  v_and_b32_dpp v26, v32, v33 quad_perm:[3,3,3,3] row_mask:0xf bank_mask:0xf
  v_and_b32_dpp v27, v32, v34 quad_perm:[3,3,3,3] row_mask:0xf bank_mask:0xf
  s_waitcnt lgkmcnt(3)
  v_mfma_f32_16x16x16_bf16 v[12:15], v[64:65], v[20:21], v[12:15]
  v_mfma_f32_16x16x16_bf16 v[16:19], v[66:67], v[20:21], v[16:19]
  s_waitcnt lgkmcnt(2)
  v_mfma_f32_16x16x16_bf16 v[12:15], v[68:69], v[22:23], v[12:15]
  v_mfma_f32_16x16x16_bf16 v[16:19], v[70:71], v[22:23], v[16:19]
  s_waitcnt lgkmcnt(1)
  v_mfma_f32_16x16x16_bf16 v[12:15], v[72:73], v[24:25], v[12:15]
  v_mfma_f32_16x16x16_bf16 v[16:19], v[74:75], v[24:25], v[16:19]
  s_waitcnt lgkmcnt(0)
  v_mfma_f32_16x16x16_bf16 v[12:15], v[76:77], v[26:27], v[12:15]
  v_mfma_f32_16x16x16_bf16 v[16:19], v[78:79], v[26:27], v[16:19]
  s_add_u32 s85, s85, 4096
  s_cmp_eq_u32 s85, s86
  s_cselect_b32 s85, s84, s85
  s_add_u32 s83, s83, 4096
  s_cmp_eq_u32 s83, s86
  s_cselect_b32 s83, s84, s83
  v_add_u32 v60, s85, v6
  s_cmp_lt_u32 s47, s77
  s_cbranch_scc1 L_vloop
  s_waitcnt vmcnt(16)
  ds_read_b32 v28, v35
  ds_read_b128 v[64:67], v60 offset:0
  ds_read_b128 v[68:71], v60 offset:1024
  ds_read_b128 v[72:75], v60 offset:2048
  ds_read_b128 v[76:79], v60 offset:3072
  v_add_u32 v35, 256, v35
  s_waitcnt lgkmcnt(4)
  v_fma_f32 v37, v28, s48, v30
  v_exp_f32 v37, v37
  s_nop 0
  v_cvt_pk_bf16_f32 v32, v37, v37
  v_add_f32 v31, v31, v37
  s_nop 0
  v_and_b32_dpp v20, v32, v33 quad_perm:[0,0,0,0] row_mask:0xf bank_mask:0xf
  v_and_b32_dpp v21, v32, v34 quad_perm:[0,0,0,0] row_mask:0xf bank_mask:0xf
  v_and_b32_dpp v22, v32, v33 quad_perm:[1,1,1,1] row_mask:0xf bank_mask:0xf
  v_and_b32_dpp v23, v32, v34 quad_perm:[1,1,1,1] row_mask:0xf bank_mask:0xf
  v_and_b32_dpp v24, v32, v33 quad_perm:[2,2,2,2] row_mask:0xf bank_mask:0xf
  v_and_b32_dpp v25, v32, v34 quad_perm:[2,2,2,2] row_mask:0xf bank_mask:0xf
  v_and_b32_dpp v26, v32, v33 quad_perm:[3,3,3,3] row_mask:0xf bank_mask:0xf
  v_and_b32_dpp v27, v32, v34 quad_perm:[3,3,3,3] row_mask:0xf bank_mask:0xf
  s_waitcnt lgkmcnt(3)
  v_mfma_f32_16x16x16_bf16 v[12:15], v[64:65], v[20:21], v[12:15]
  v_mfma_f32_16x16x16_bf16 v[16:19], v[66:67], v[20:21], v[16:19]
  s_waitcnt lgkmcnt(2)
  v_mfma_f32_16x16x16_bf16 v[12:15], v[68:69], v[22:23], v[12:15]
  v_mfma_f32_16x16x16_bf16 v[16:19], v[70:71], v[22:23], v[16:19]
  s_waitcnt lgkmcnt(1)
  v_mfma_f32_16x16x16_bf16 v[12:15], v[72:73], v[24:25], v[12:15]
  v_mfma_f32_16x16x16_bf16 v[16:19], v[74:75], v[24:25], v[16:19]
  s_waitcnt lgkmcnt(0)
  v_mfma_f32_16x16x16_bf16 v[12:15], v[76:77], v[26:27], v[12:15]
  v_mfma_f32_16x16x16_bf16 v[16:19], v[78:79], v[26:27], v[16:19]
  s_add_u32 s85, s85, 4096
  s_cmp_eq_u32 s85, s86
  s_cselect_b32 s85, s84, s85
  v_add_u32 v60, s85, v6
  s_mov_b32 s57, 20000
L_mchk:
  v_cmp_ne_u32 vcc, v9, v39
  v_cmp_ne_u32 s[58:59], v11, v39
  s_sub_u32 s57, s57, 1
  s_or_b64 vcc, vcc, s[58:59]
  s_cbranch_scc0 L_mok
  s_cmp_eq_u32 s57, 0
  s_cbranch_scc1 L_mok
  s_sleep 2
  buffer_load_dwordx2 v[8:9], v36, s[36:39], s55 offen sc1
  buffer_load_dwordx2 v[10:11], v36, s[36:39], s55 offen offset:512 sc1
  s_waitcnt vmcnt(0)
  s_branch L_mchk
L_mok:
  v_max_f32 v8, v8, v10
  v_mul_u32_u24 v40, 672, v1
  v_mul_u32_u24 v41, 144, v3
  v_max_f32_dpp v8, v8, v8 quad_perm:[1,0,3,2] row_mask:0xf bank_mask:0xf
  v_add3_u32 v40, v40, v41, s54
  v_lshl_add_u32 v40, v4, 2, v40
  v_max_f32_dpp v8, v8, v8 quad_perm:[2,3,0,1] row_mask:0xf bank_mask:0xf
  v_mov_b32 v9, v8
  s_nop 1
  v_permlane16_swap_b32 v8, v9
  s_nop 0
  v_max_f32 v8, v8, v9
  v_mov_b32 v9, v8
  s_nop 1
  v_permlane32_swap_b32 v8, v9
  s_nop 0
  v_max_f32 v8, v8, v9
  v_fma_f32 v8, v8, s48, v30
  v_exp_f32 v8, -v8
  v_mov_b32 v42, 149632
  v_lshl_add_u32 v42, v1, 4, v42
  s_lshl_b32 s55, s22, 2
  v_add_u32 v42, s55, v42
  s_mul_i32 s55, s22, 672
  s_add_u32 s55, s55, 114688
  v_lshl_add_u32 v41, v2, 3, v41
  v_add_u32 v41, s55, v41
  s_lshl_b32 s55, s22, 4
  s_add_u32 s55, s55, 149632
  v_mov_b32 v43, s55
  v_lshrrev_b32 v44, 5, v0
  v_lshlrev_b32 v44, 14, v44
  v_and_b32 v45, 31, v0
  v_lshl_add_u32 v44, v45, 4, v44
  s_lshl_b32 s55, s20, 2
  s_add_u32 s55, s55, s22
  s_lshl_b32 s55, s55, 15
  s_lshl_b32 s56, s21, 9
  s_add_u32 s55, s55, s56
  s_add_u32 s88, s55, 1048576
  s_lshl_b32 s56, s22, 6
  s_add_u32 s56, s56, s20
  s_lshl_b32 s56, s56, 11
  s_lshl_b32 s58, s21, 6
  s_add_u32 s56, s56, s58
  s_add_u32 s89, s56, 4194304
  v_lshrrev_b32 v46, 3, v0
  v_lshlrev_b32 v46, 14, v46
  v_and_b32 v52, 7, v0
  v_lshl_add_u32 v46, v52, 3, v46
  s_lshl_b32 s90, s50, 14
  s_add_u32 s90, s90, 1048576
  s_lshl_b32 s91, s2, 11
  s_add_u32 s91, s91, 4194304
  v_and_b32 v47, 31, v0
  v_lshlrev_b32 v47, 6, v47
  v_lshrrev_b32 v48, 1, v4
  v_lshlrev_b32 v48, 2, v48
  v_lshl_add_u32 v48, v3, 3, v48
  v_mov_b32 v49, 0x01000100
  v_mov_b32 v50, 0x03020302
  s_mov_b32 s92, 0xaaaaaaaa
  s_mov_b32 s93, 0xaaaaaaaa
  v_cndmask_b32 v49, v49, v50, s[92:93]
  v_lshrrev_b32 v50, 2, v0
  v_lshlrev_b32 v50, 12, v50
  v_lshl_add_u32 v50, v4, 4, v50
  s_lshl_b32 s92, s51, 16
  s_lshl_b32 s93, s50, 6
  s_add_u32 s92, s92, s93
  s_add_u32 s92, s92, 2097152
  s_waitcnt vmcnt(12)
  ds_read_b32 v28, v35
  ds_read_b128 v[64:67], v60 offset:0
  ds_read_b128 v[68:71], v60 offset:1024
  ds_read_b128 v[72:75], v60 offset:2048
  ds_read_b128 v[76:79], v60 offset:3072
  v_add_u32 v35, 256, v35
  s_waitcnt lgkmcnt(4)
  v_fma_f32 v37, v28, s48, v30
  v_exp_f32 v37, v37
  s_nop 0
  v_cvt_pk_bf16_f32 v32, v37, v37
  v_add_f32 v31, v31, v37
  s_nop 0
  v_and_b32_dpp v20, v32, v33 quad_perm:[0,0,0,0] row_mask:0xf bank_mask:0xf
  v_and_b32_dpp v21, v32, v34 quad_perm:[0,0,0,0] row_mask:0xf bank_mask:0xf
  v_and_b32_dpp v22, v32, v33 quad_perm:[1,1,1,1] row_mask:0xf bank_mask:0xf
  v_and_b32_dpp v23, v32, v34 quad_perm:[1,1,1,1] row_mask:0xf bank_mask:0xf
  v_and_b32_dpp v24, v32, v33 quad_perm:[2,2,2,2] row_mask:0xf bank_mask:0xf
  v_and_b32_dpp v25, v32, v34 quad_perm:[2,2,2,2] row_mask:0xf bank_mask:0xf
  v_and_b32_dpp v26, v32, v33 quad_perm:[3,3,3,3] row_mask:0xf bank_mask:0xf
  v_and_b32_dpp v27, v32, v34 quad_perm:[3,3,3,3] row_mask:0xf bank_mask:0xf
  s_waitcnt lgkmcnt(3)
  v_mfma_f32_16x16x16_bf16 v[12:15], v[64:65], v[20:21], v[12:15]
  v_mfma_f32_16x16x16_bf16 v[16:19], v[66:67], v[20:21], v[16:19]
  s_waitcnt lgkmcnt(2)
  v_mfma_f32_16x16x16_bf16 v[12:15], v[68:69], v[22:23], v[12:15]
  v_mfma_f32_16x16x16_bf16 v[16:19], v[70:71], v[22:23], v[16:19]
  s_waitcnt lgkmcnt(1)
  v_mfma_f32_16x16x16_bf16 v[12:15], v[72:73], v[24:25], v[12:15]
  v_mfma_f32_16x16x16_bf16 v[16:19], v[74:75], v[24:25], v[16:19]
  s_waitcnt lgkmcnt(0)
  v_mfma_f32_16x16x16_bf16 v[12:15], v[76:77], v[26:27], v[12:15]
  v_mfma_f32_16x16x16_bf16 v[16:19], v[78:79], v[26:27], v[16:19]
  s_add_u32 s85, s85, 4096
  s_cmp_eq_u32 s85, s86
  s_cselect_b32 s85, s84, s85
  v_add_u32 v60, s85, v6
  s_waitcnt vmcnt(8)
  ds_read_b32 v28, v35
  ds_read_b128 v[64:67], v60 offset:0
  ds_read_b128 v[68:71], v60 offset:1024
  ds_read_b128 v[72:75], v60 offset:2048
  ds_read_b128 v[76:79], v60 offset:3072
  v_add_u32 v35, 256, v35
  s_waitcnt lgkmcnt(4)
  v_fma_f32 v37, v28, s48, v30
  v_exp_f32 v37, v37
  s_nop 0
  v_cvt_pk_bf16_f32 v32, v37, v37
  v_add_f32 v31, v31, v37
  s_nop 0
  v_and_b32_dpp v20, v32, v33 quad_perm:[0,0,0,0] row_mask:0xf bank_mask:0xf
  v_and_b32_dpp v21, v32, v34 quad_perm:[0,0,0,0] row_mask:0xf bank_mask:0xf
  v_and_b32_dpp v22, v32, v33 quad_perm:[1,1,1,1] row_mask:0xf bank_mask:0xf
  v_and_b32_dpp v23, v32, v34 quad_perm:[1,1,1,1] row_mask:0xf bank_mask:0xf
  v_and_b32_dpp v24, v32, v33 quad_perm:[2,2,2,2] row_mask:0xf bank_mask:0xf
  v_and_b32_dpp v25, v32, v34 quad_perm:[2,2,2,2] row_mask:0xf bank_mask:0xf
  v_and_b32_dpp v26, v32, v33 quad_perm:[3,3,3,3] row_mask:0xf bank_mask:0xf
  v_and_b32_dpp v27, v32, v34 quad_perm:[3,3,3,3] row_mask:0xf bank_mask:0xf
  s_waitcnt lgkmcnt(3)
  v_mfma_f32_16x16x16_bf16 v[12:15], v[64:65], v[20:21], v[12:15]
  v_mfma_f32_16x16x16_bf16 v[16:19], v[66:67], v[20:21], v[16:19]
  s_waitcnt lgkmcnt(2)
  v_mfma_f32_16x16x16_bf16 v[12:15], v[68:69], v[22:23], v[12:15]
  v_mfma_f32_16x16x16_bf16 v[16:19], v[70:71], v[22:23], v[16:19]
  s_waitcnt lgkmcnt(1)
  v_mfma_f32_16x16x16_bf16 v[12:15], v[72:73], v[24:25], v[12:15]
  v_mfma_f32_16x16x16_bf16 v[16:19], v[74:75], v[24:25], v[16:19]
  s_waitcnt lgkmcnt(0)
  v_mfma_f32_16x16x16_bf16 v[12:15], v[76:77], v[26:27], v[12:15]
  v_mfma_f32_16x16x16_bf16 v[16:19], v[78:79], v[26:27], v[16:19]
  s_add_u32 s85, s85, 4096
  s_cmp_eq_u32 s85, s86
  s_cselect_b32 s85, s84, s85
  v_add_u32 v60, s85, v6
  s_waitcnt vmcnt(4)
  ds_read_b32 v28, v35
  ds_read_b128 v[64:67], v60 offset:0
  ds_read_b128 v[68:71], v60 offset:1024
  ds_read_b128 v[72:75], v60 offset:2048
  ds_read_b128 v[76:79], v60 offset:3072
  v_add_u32 v35, 256, v35
  s_waitcnt lgkmcnt(4)
  v_fma_f32 v37, v28, s48, v30
  v_exp_f32 v37, v37
  s_nop 0
  v_cvt_pk_bf16_f32 v32, v37, v37
  v_add_f32 v31, v31, v37
  s_nop 0
  v_and_b32_dpp v20, v32, v33 quad_perm:[0,0,0,0] row_mask:0xf bank_mask:0xf
  v_and_b32_dpp v21, v32, v34 quad_perm:[0,0,0,0] row_mask:0xf bank_mask:0xf
  v_and_b32_dpp v22, v32, v33 quad_perm:[1,1,1,1] row_mask:0xf bank_mask:0xf
  v_and_b32_dpp v23, v32, v34 quad_perm:[1,1,1,1] row_mask:0xf bank_mask:0xf
  v_and_b32_dpp v24, v32, v33 quad_perm:[2,2,2,2] row_mask:0xf bank_mask:0xf
  v_and_b32_dpp v25, v32, v34 quad_perm:[2,2,2,2] row_mask:0xf bank_mask:0xf
  v_and_b32_dpp v26, v32, v33 quad_perm:[3,3,3,3] row_mask:0xf bank_mask:0xf
  v_and_b32_dpp v27, v32, v34 quad_perm:[3,3,3,3] row_mask:0xf bank_mask:0xf
  s_waitcnt lgkmcnt(3)
  v_mfma_f32_16x16x16_bf16 v[12:15], v[64:65], v[20:21], v[12:15]
  v_mfma_f32_16x16x16_bf16 v[16:19], v[66:67], v[20:21], v[16:19]
  s_waitcnt lgkmcnt(2)
  v_mfma_f32_16x16x16_bf16 v[12:15], v[68:69], v[22:23], v[12:15]
  v_mfma_f32_16x16x16_bf16 v[16:19], v[70:71], v[22:23], v[16:19]
  s_waitcnt lgkmcnt(1)
  v_mfma_f32_16x16x16_bf16 v[12:15], v[72:73], v[24:25], v[12:15]
  v_mfma_f32_16x16x16_bf16 v[16:19], v[74:75], v[24:25], v[16:19]
  s_waitcnt lgkmcnt(0)
  v_mfma_f32_16x16x16_bf16 v[12:15], v[76:77], v[26:27], v[12:15]
  v_mfma_f32_16x16x16_bf16 v[16:19], v[78:79], v[26:27], v[16:19]
  s_add_u32 s85, s85, 4096
  s_cmp_eq_u32 s85, s86
  s_cselect_b32 s85, s84, s85
  v_add_u32 v60, s85, v6
  s_waitcnt vmcnt(0)
  ds_read_b32 v28, v35
  ds_read_b128 v[64:67], v60 offset:0
  ds_read_b128 v[68:71], v60 offset:1024
  ds_read_b128 v[72:75], v60 offset:2048
  ds_read_b128 v[76:79], v60 offset:3072
  v_add_u32 v35, 256, v35
  s_waitcnt lgkmcnt(4)
  v_fma_f32 v37, v28, s48, v30
  v_exp_f32 v37, v37
  s_nop 0
  v_cvt_pk_bf16_f32 v32, v37, v37
  v_add_f32 v31, v31, v37
  s_nop 0
  v_and_b32_dpp v20, v32, v33 quad_perm:[0,0,0,0] row_mask:0xf bank_mask:0xf
  v_and_b32_dpp v21, v32, v34 quad_perm:[0,0,0,0] row_mask:0xf bank_mask:0xf
  v_and_b32_dpp v22, v32, v33 quad_perm:[1,1,1,1] row_mask:0xf bank_mask:0xf
  v_and_b32_dpp v23, v32, v34 quad_perm:[1,1,1,1] row_mask:0xf bank_mask:0xf
  v_and_b32_dpp v24, v32, v33 quad_perm:[2,2,2,2] row_mask:0xf bank_mask:0xf
  v_and_b32_dpp v25, v32, v34 quad_perm:[2,2,2,2] row_mask:0xf bank_mask:0xf
  v_and_b32_dpp v26, v32, v33 quad_perm:[3,3,3,3] row_mask:0xf bank_mask:0xf
  v_and_b32_dpp v27, v32, v34 quad_perm:[3,3,3,3] row_mask:0xf bank_mask:0xf
  s_waitcnt lgkmcnt(3)
  v_mfma_f32_16x16x16_bf16 v[12:15], v[64:65], v[20:21], v[12:15]
  v_mfma_f32_16x16x16_bf16 v[16:19], v[66:67], v[20:21], v[16:19]
  s_waitcnt lgkmcnt(2)
  v_mfma_f32_16x16x16_bf16 v[12:15], v[68:69], v[22:23], v[12:15]
  v_mfma_f32_16x16x16_bf16 v[16:19], v[70:71], v[22:23], v[16:19]
  s_waitcnt lgkmcnt(1)
  v_mfma_f32_16x16x16_bf16 v[12:15], v[72:73], v[24:25], v[12:15]
  v_mfma_f32_16x16x16_bf16 v[16:19], v[74:75], v[24:25], v[16:19]
  s_waitcnt lgkmcnt(0)
  v_mfma_f32_16x16x16_bf16 v[12:15], v[76:77], v[26:27], v[12:15]
  v_mfma_f32_16x16x16_bf16 v[16:19], v[78:79], v[26:27], v[16:19]
  s_add_u32 s85, s85, 4096
  s_cmp_eq_u32 s85, s86
  s_cselect_b32 s85, s84, s85
  v_add_u32 v60, s85, v6
  s_cmp_lg_u32 s22, 0
  s_cbranch_scc1 L_nowo
  v_lshlrev_b32 v5, 12, v3
  v_lshl_add_u32 v5, v2, 4, v5
  buffer_load_dwordx4 v[80:83], v5, s[32:35], 0 offen offset:0 nt
  buffer_load_dwordx4 v[84:87], v5, s[32:35], 0 offen offset:1024 nt
  buffer_load_dwordx4 v[88:91], v5, s[32:35], 0 offen offset:2048 nt
  buffer_load_dwordx4 v[92:95], v5, s[32:35], 0 offen offset:3072 nt
  s_mov_b32 s58, 16384
  buffer_load_dwordx4 v[96:99], v5, s[32:35], s58 offen offset:0 nt
  buffer_load_dwordx4 v[100:103], v5, s[32:35], s58 offen offset:1024 nt
  buffer_load_dwordx4 v[104:107], v5, s[32:35], s58 offen offset:2048 nt
  buffer_load_dwordx4 v[108:111], v5, s[32:35], s58 offen offset:3072 nt
  s_mov_b32 s58, 32768
  buffer_load_dwordx4 v[112:115], v5, s[32:35], s58 offen offset:0 nt
  buffer_load_dwordx4 v[116:119], v5, s[32:35], s58 offen offset:1024 nt
  buffer_load_dwordx4 v[120:123], v5, s[32:35], s58 offen offset:2048 nt
  buffer_load_dwordx4 v[124:127], v5, s[32:35], s58 offen offset:3072 nt
  s_mov_b32 s58, 49152
  buffer_load_dwordx4 v[128:131], v5, s[32:35], s58 offen offset:0 nt
  buffer_load_dwordx4 v[132:135], v5, s[32:35], s58 offen offset:1024 nt
  buffer_load_dwordx4 v[136:139], v5, s[32:35], s58 offen offset:2048 nt
  buffer_load_dwordx4 v[140:143], v5, s[32:35], s58 offen offset:3072 nt
L_nowo:
  v_add_f32_dpp v31, v31, v31 quad_perm:[1,0,3,2] row_mask:0xf bank_mask:0xf
  v_mov_b32 v25, v39
  v_mov_b32 v27, v39
  v_add_f32_dpp v31, v31, v31 quad_perm:[2,3,0,1] row_mask:0xf bank_mask:0xf
  s_nop 0
  v_mov_b32 v10, v31
  v_mul_f32 v12, v12, v8
  v_mul_f32 v13, v13, v8
  v_permlane16_swap_b32 v31, v10
  v_mul_f32 v14, v14, v8
  v_mul_f32 v15, v15, v8
  v_add_f32 v31, v31, v10
  v_mov_b32 v10, v31
  v_mul_f32 v16, v16, v8
  v_mul_f32 v17, v17, v8
  v_permlane32_swap_b32 v31, v10
  v_mul_f32 v18, v18, v8
  v_mul_f32 v19, v19, v8
  v_add_f32 v31, v31, v10
  ds_write_b32 v40, v12 offset:0
  ds_write_b32 v40, v16 offset:16
  ds_write_b32 v40, v13 offset:32
  ds_write_b32 v40, v17 offset:48
  ds_write_b32 v40, v14 offset:64
  ds_write_b32 v40, v18 offset:80
  ds_write_b32 v40, v15 offset:96
  ds_write_b32 v40, v19 offset:112
  v_mul_f32 v31, v31, v8
  ds_write_b32 v42, v31
  s_waitcnt lgkmcnt(0)
  s_barrier
  ds_read_b64 v[12:13], v41 offset:0
  ds_read_b64 v[14:15], v41 offset:8448
  ds_read_b64 v[16:17], v41 offset:16896
  ds_read_b64 v[18:19], v41 offset:25344
  ds_read_b128 v[20:23], v43
  s_waitcnt lgkmcnt(1)
  v_add_f32 v12, v12, v14
  v_add_f32 v13, v13, v15
  v_add_f32 v16, v16, v18
  v_add_f32 v17, v17, v19
  v_add_f32 v24, v12, v16
  v_add_f32 v26, v13, v17
  buffer_store_dwordx4 v[24:27], v44, s[36:39], s88 offen sc1
  s_waitcnt lgkmcnt(0)
  v_add_f32 v20, v20, v21
  v_add_f32 v22, v22, v23
  v_add_f32 v38, v20, v22
  buffer_store_dwordx2 v[38:39], v46, s[36:39], s89 offen sc1
  s_cmp_lg_u32 s22, 0
  s_cbranch_scc1 L_wavedone
  s_add_u32 s53, s90, 4096
  s_add_u32 s54, s90, 8192
  s_add_u32 s55, s90, 12288
  s_mov_b32 s57, 20000
  s_mov_b32 s87, 15
  s_mov_b32 s94, 0
  v_mov_b32 v8, v39
  v_mov_b32 v9, v39
L_cpoll:
  s_cmp_eq_u32 s87, 0
  s_cbranch_scc1 L_cnolg
  buffer_load_dwordx2 v[30:31], v47, s[36:39], s91 offen sc1
L_cnolg:
  s_sub_u32 s57, s57, 1
  s_waitcnt vmcnt(0)
  v_cmp_eq_u32 vcc, v31, v39
  s_cmp_le_i32 s57, 0
  s_cselect_b32 s93, -1, vcc_lo
  s_mov_b32 s95, s94
  s_mov_b32 s94, 0
  s_bitcmp0_b32 s87, 0
  s_cbranch_scc1 L_ci0
  s_bfe_u32 s58, s93, 0x80000
  s_cmp_lg_u32 s58, 0xff
  s_cbranch_scc1 L_ci0
  buffer_load_dwordx4 v[144:147], v6, s[36:39], s90 offen offset:0 sc1
  buffer_load_dwordx4 v[148:151], v6, s[36:39], s90 offen offset:1024 sc1
  buffer_load_dwordx4 v[152:155], v6, s[36:39], s90 offen offset:2048 sc1
  buffer_load_dwordx4 v[156:159], v6, s[36:39], s90 offen offset:3072 sc1
  s_bitset0_b32 s87, 0
  s_bitset1_b32 s94, 0
L_ci0:
  s_bitcmp0_b32 s87, 1
  s_cbranch_scc1 L_ci1
  s_bfe_u32 s58, s93, 0x80008
  s_cmp_lg_u32 s58, 0xff
  s_cbranch_scc1 L_ci1
  buffer_load_dwordx4 v[160:163], v6, s[36:39], s53 offen offset:0 sc1
  buffer_load_dwordx4 v[164:167], v6, s[36:39], s53 offen offset:1024 sc1
  buffer_load_dwordx4 v[168:171], v6, s[36:39], s53 offen offset:2048 sc1
  buffer_load_dwordx4 v[172:175], v6, s[36:39], s53 offen offset:3072 sc1
  s_bitset0_b32 s87, 1
  s_bitset1_b32 s94, 1
L_ci1:
  s_bitcmp0_b32 s87, 2
  s_cbranch_scc1 L_ci2
  s_bfe_u32 s58, s93, 0x80010
  s_cmp_lg_u32 s58, 0xff
  s_cbranch_scc1 L_ci2
  buffer_load_dwordx4 v[176:179], v6, s[36:39], s54 offen offset:0 sc1
  buffer_load_dwordx4 v[180:183], v6, s[36:39], s54 offen offset:1024 sc1
  buffer_load_dwordx4 v[184:187], v6, s[36:39], s54 offen offset:2048 sc1
  buffer_load_dwordx4 v[188:191], v6, s[36:39], s54 offen offset:3072 sc1
  s_bitset0_b32 s87, 2
  s_bitset1_b32 s94, 2
L_ci2:
  s_bitcmp0_b32 s87, 3
  s_cbranch_scc1 L_ci3
  s_bfe_u32 s58, s93, 0x80018
  s_cmp_lg_u32 s58, 0xff
  s_cbranch_scc1 L_ci3
  buffer_load_dwordx4 v[192:195], v6, s[36:39], s55 offen offset:0 sc1
  buffer_load_dwordx4 v[196:199], v6, s[36:39], s55 offen offset:1024 sc1
  buffer_load_dwordx4 v[200:203], v6, s[36:39], s55 offen offset:2048 sc1
  buffer_load_dwordx4 v[204:207], v6, s[36:39], s55 offen offset:3072 sc1
  s_bitset0_b32 s87, 3
  s_bitset1_b32 s94, 3
L_ci3:
  s_bitcmp0_b32 s95, 0
  s_cbranch_scc1 L_cs0
  v_min3_u32 v8, v8, v145, v147
  v_max3_u32 v9, v9, v145, v147
  v_min3_u32 v8, v8, v149, v151
  v_max3_u32 v9, v9, v149, v151
  v_min3_u32 v8, v8, v153, v155
  v_max3_u32 v9, v9, v153, v155
  v_min3_u32 v8, v8, v157, v159
  v_max3_u32 v9, v9, v157, v159
  v_add_f32 v14, v144, v148
  v_add_f32 v15, v146, v150
  v_add_f32 v16, v152, v156
  v_add_f32 v17, v154, v158
  v_add_f32 v64, v14, v16
  v_add_f32 v65, v15, v17
L_cs0:
  s_bitcmp0_b32 s95, 1
  s_cbranch_scc1 L_cs1
  v_min3_u32 v8, v8, v161, v163
  v_max3_u32 v9, v9, v161, v163
  v_min3_u32 v8, v8, v165, v167
  v_max3_u32 v9, v9, v165, v167
  v_min3_u32 v8, v8, v169, v171
  v_max3_u32 v9, v9, v169, v171
  v_min3_u32 v8, v8, v173, v175
  v_max3_u32 v9, v9, v173, v175
  v_add_f32 v14, v160, v164
  v_add_f32 v15, v162, v166
  v_add_f32 v16, v168, v172
  v_add_f32 v17, v170, v174
  v_add_f32 v66, v14, v16
  v_add_f32 v67, v15, v17
L_cs1:
  s_bitcmp0_b32 s95, 2
  s_cbranch_scc1 L_cs2
  v_min3_u32 v8, v8, v177, v179
  v_max3_u32 v9, v9, v177, v179
  v_min3_u32 v8, v8, v181, v183
  v_max3_u32 v9, v9, v181, v183
  v_min3_u32 v8, v8, v185, v187
  v_max3_u32 v9, v9, v185, v187
  v_min3_u32 v8, v8, v189, v191
  v_max3_u32 v9, v9, v189, v191
  v_add_f32 v14, v176, v180
  v_add_f32 v15, v178, v182
  v_add_f32 v16, v184, v188
  v_add_f32 v17, v186, v190
  v_add_f32 v68, v14, v16
  v_add_f32 v69, v15, v17
L_cs2:
  s_bitcmp0_b32 s95, 3
  s_cbranch_scc1 L_cs3
  v_min3_u32 v8, v8, v193, v195
  v_max3_u32 v9, v9, v193, v195
  v_min3_u32 v8, v8, v197, v199
  v_max3_u32 v9, v9, v197, v199
  v_min3_u32 v8, v8, v201, v203
  v_max3_u32 v9, v9, v201, v203
  v_min3_u32 v8, v8, v205, v207
  v_max3_u32 v9, v9, v205, v207
  v_add_f32 v14, v192, v196
  v_add_f32 v15, v194, v198
  v_add_f32 v16, v200, v204
  v_add_f32 v17, v202, v206
  v_add_f32 v70, v14, v16
  v_add_f32 v71, v15, v17
L_cs3:
  s_cmp_lg_u32 s94, 0
  s_cbranch_scc1 L_cwait
  s_cmp_eq_u32 s87, 0
  s_cbranch_scc1 L_call
  s_sleep 2
  s_branch L_cpoll
L_cwait:
  s_cmp_lg_u32 s87, 0
  s_cbranch_scc1 L_cpoll
  v_add_f32_dpp v28, v30, v30 quad_perm:[1,0,3,2] row_mask:0xf bank_mask:0xf
  s_nop 1
  v_add_f32_dpp v28, v28, v28 quad_perm:[2,3,0,1] row_mask:0xf bank_mask:0xf
  s_nop 1
  v_add_f32_dpp v28, v28, v28 row_ror:4 row_mask:0xf bank_mask:0xf
  s_nop 1
  v_add_f32_dpp v28, v28, v28 row_ror:8 row_mask:0xf bank_mask:0xf
  s_nop 0
  v_mov_b32 v29, v28
  s_nop 1
  v_permlane16_swap_b32 v28, v29
  s_nop 0
  v_add_f32 v28, v28, v29
  v_rcp_f32 v28, v28
  v_swap_b32 v82, v84
  v_swap_b32 v83, v85
  v_swap_b32 v90, v92
  v_swap_b32 v91, v93
  v_swap_b32 v98, v100
  v_swap_b32 v99, v101
  v_swap_b32 v106, v108
  v_swap_b32 v107, v109
  v_swap_b32 v114, v116
  v_swap_b32 v115, v117
  v_swap_b32 v122, v124
  v_swap_b32 v123, v125
  v_swap_b32 v130, v132
  v_swap_b32 v131, v133
  v_swap_b32 v138, v140
  v_swap_b32 v139, v141
  s_branch L_cpoll
L_call:
  v_add_f32 v12, v64, v66
  v_add_f32 v13, v65, v67
  v_add_f32 v14, v68, v70
  v_add_f32 v15, v69, v71
  v_cmp_ne_u32 vcc, v8, v9
  v_add_f32 v12, v12, v14
  v_add_f32 v13, v13, v15
  v_mov_b32 v14, v12
  v_mov_b32 v15, v13
  s_cmp_le_i32 s57, 0
  s_cbranch_scc1 L_cdone
  s_cmp_eq_u64 vcc, 0
  s_cbranch_scc1 L_cdone
  v_mov_b32 v8, v39
  v_mov_b32 v9, v39
  buffer_load_dwordx4 v[144:147], v6, s[36:39], s90 offen offset:0 sc1
  buffer_load_dwordx4 v[148:151], v6, s[36:39], s90 offen offset:1024 sc1
  buffer_load_dwordx4 v[152:155], v6, s[36:39], s90 offen offset:2048 sc1
  buffer_load_dwordx4 v[156:159], v6, s[36:39], s90 offen offset:3072 sc1
  buffer_load_dwordx4 v[160:163], v6, s[36:39], s53 offen offset:0 sc1
  buffer_load_dwordx4 v[164:167], v6, s[36:39], s53 offen offset:1024 sc1
  buffer_load_dwordx4 v[168:171], v6, s[36:39], s53 offen offset:2048 sc1
  buffer_load_dwordx4 v[172:175], v6, s[36:39], s53 offen offset:3072 sc1
  buffer_load_dwordx4 v[176:179], v6, s[36:39], s54 offen offset:0 sc1
  buffer_load_dwordx4 v[180:183], v6, s[36:39], s54 offen offset:1024 sc1
  buffer_load_dwordx4 v[184:187], v6, s[36:39], s54 offen offset:2048 sc1
  buffer_load_dwordx4 v[188:191], v6, s[36:39], s54 offen offset:3072 sc1
  buffer_load_dwordx4 v[192:195], v6, s[36:39], s55 offen offset:0 sc1
  buffer_load_dwordx4 v[196:199], v6, s[36:39], s55 offen offset:1024 sc1
  buffer_load_dwordx4 v[200:203], v6, s[36:39], s55 offen offset:2048 sc1
  buffer_load_dwordx4 v[204:207], v6, s[36:39], s55 offen offset:3072 sc1
  s_mov_b32 s94, 15
  s_branch L_cpoll
L_cdone:
  v_permlane32_swap_b32 v12, v14
  v_permlane32_swap_b32 v13, v15
  s_lshl_b32 s55, s75, 10
  v_add_f32 v12, v12, v14
  v_add_f32 v13, v13, v15
  v_mul_f32 v12, v12, v28
  v_mul_f32 v13, v13, v28
  v_cvt_pk_bf16_f32 v12, v12, v13
  ds_bpermute_b32 v28, v48, v12 offset:0
  ds_bpermute_b32 v29, v48, v12 offset:32
  ds_bpermute_b32 v30, v48, v12 offset:64
  ds_bpermute_b32 v31, v48, v12 offset:96
  s_add_u32 s55, s55, 2097152
  s_mov_b32 s40, s14
  s_mov_b32 s41, s15
  s_mov_b32 s42, 1024
  s_mov_b32 s43, 0x00020000
  s_waitcnt lgkmcnt(3)
  v_perm_b32 v32, v28, v28, v49
  s_nop 1
  v_and_b32_dpp v20, v32, v33 quad_perm:[0,0,0,0] row_mask:0xf bank_mask:0xf
  v_and_b32_dpp v21, v32, v34 quad_perm:[0,0,0,0] row_mask:0xf bank_mask:0xf
  v_and_b32_dpp v22, v32, v33 quad_perm:[1,1,1,1] row_mask:0xf bank_mask:0xf
  v_and_b32_dpp v23, v32, v34 quad_perm:[1,1,1,1] row_mask:0xf bank_mask:0xf
  v_and_b32_dpp v24, v32, v33 quad_perm:[2,2,2,2] row_mask:0xf bank_mask:0xf
  v_and_b32_dpp v25, v32, v34 quad_perm:[2,2,2,2] row_mask:0xf bank_mask:0xf
  v_and_b32_dpp v26, v32, v33 quad_perm:[3,3,3,3] row_mask:0xf bank_mask:0xf
  v_and_b32_dpp v27, v32, v34 quad_perm:[3,3,3,3] row_mask:0xf bank_mask:0xf
  s_nop 0
  v_mfma_f32_16x16x32_bf16 v[12:15], v[80:83], v[20:23], 0
  v_mfma_f32_16x16x32_bf16 v[16:19], v[84:87], v[20:23], 0
  v_mfma_f32_16x16x32_bf16 v[12:15], v[88:91], v[24:27], v[12:15]
  v_mfma_f32_16x16x32_bf16 v[16:19], v[92:95], v[24:27], v[16:19]
  s_waitcnt lgkmcnt(2)
  v_perm_b32 v32, v29, v29, v49
  s_nop 1
  v_and_b32_dpp v20, v32, v33 quad_perm:[0,0,0,0] row_mask:0xf bank_mask:0xf
  v_and_b32_dpp v21, v32, v34 quad_perm:[0,0,0,0] row_mask:0xf bank_mask:0xf
  v_and_b32_dpp v22, v32, v33 quad_perm:[1,1,1,1] row_mask:0xf bank_mask:0xf
  v_and_b32_dpp v23, v32, v34 quad_perm:[1,1,1,1] row_mask:0xf bank_mask:0xf
  v_and_b32_dpp v24, v32, v33 quad_perm:[2,2,2,2] row_mask:0xf bank_mask:0xf
  v_and_b32_dpp v25, v32, v34 quad_perm:[2,2,2,2] row_mask:0xf bank_mask:0xf
  v_and_b32_dpp v26, v32, v33 quad_perm:[3,3,3,3] row_mask:0xf bank_mask:0xf
  v_and_b32_dpp v27, v32, v34 quad_perm:[3,3,3,3] row_mask:0xf bank_mask:0xf
  v_mfma_f32_16x16x32_bf16 v[12:15], v[96:99], v[20:23], v[12:15]
  v_mfma_f32_16x16x32_bf16 v[16:19], v[100:103], v[20:23], v[16:19]
  v_mfma_f32_16x16x32_bf16 v[12:15], v[104:107], v[24:27], v[12:15]
  v_mfma_f32_16x16x32_bf16 v[16:19], v[108:111], v[24:27], v[16:19]
  s_waitcnt lgkmcnt(1)
  v_perm_b32 v32, v30, v30, v49
  s_nop 1
  v_and_b32_dpp v20, v32, v33 quad_perm:[0,0,0,0] row_mask:0xf bank_mask:0xf
  v_and_b32_dpp v21, v32, v34 quad_perm:[0,0,0,0] row_mask:0xf bank_mask:0xf
  v_and_b32_dpp v22, v32, v33 quad_perm:[1,1,1,1] row_mask:0xf bank_mask:0xf
  v_and_b32_dpp v23, v32, v34 quad_perm:[1,1,1,1] row_mask:0xf bank_mask:0xf
  v_and_b32_dpp v24, v32, v33 quad_perm:[2,2,2,2] row_mask:0xf bank_mask:0xf
  v_and_b32_dpp v25, v32, v34 quad_perm:[2,2,2,2] row_mask:0xf bank_mask:0xf
  v_and_b32_dpp v26, v32, v33 quad_perm:[3,3,3,3] row_mask:0xf bank_mask:0xf
  v_and_b32_dpp v27, v32, v34 quad_perm:[3,3,3,3] row_mask:0xf bank_mask:0xf
  v_mfma_f32_16x16x32_bf16 v[12:15], v[112:115], v[20:23], v[12:15]
  v_mfma_f32_16x16x32_bf16 v[16:19], v[116:119], v[20:23], v[16:19]
  v_mfma_f32_16x16x32_bf16 v[12:15], v[120:123], v[24:27], v[12:15]
  v_mfma_f32_16x16x32_bf16 v[16:19], v[124:127], v[24:27], v[16:19]
  s_waitcnt lgkmcnt(0)
  v_perm_b32 v32, v31, v31, v49
  s_nop 1
  v_and_b32_dpp v20, v32, v33 quad_perm:[0,0,0,0] row_mask:0xf bank_mask:0xf
  v_and_b32_dpp v21, v32, v34 quad_perm:[0,0,0,0] row_mask:0xf bank_mask:0xf
  v_and_b32_dpp v22, v32, v33 quad_perm:[1,1,1,1] row_mask:0xf bank_mask:0xf
  v_and_b32_dpp v23, v32, v34 quad_perm:[1,1,1,1] row_mask:0xf bank_mask:0xf
  v_and_b32_dpp v24, v32, v33 quad_perm:[2,2,2,2] row_mask:0xf bank_mask:0xf
  v_and_b32_dpp v25, v32, v34 quad_perm:[2,2,2,2] row_mask:0xf bank_mask:0xf
  v_and_b32_dpp v26, v32, v33 quad_perm:[3,3,3,3] row_mask:0xf bank_mask:0xf
  v_and_b32_dpp v27, v32, v34 quad_perm:[3,3,3,3] row_mask:0xf bank_mask:0xf
  v_mfma_f32_16x16x32_bf16 v[12:15], v[128:131], v[20:23], v[12:15]
  v_mfma_f32_16x16x32_bf16 v[16:19], v[132:135], v[20:23], v[16:19]
  v_mfma_f32_16x16x32_bf16 v[12:15], v[136:139], v[24:27], v[12:15]
  v_mfma_f32_16x16x32_bf16 v[16:19], v[140:143], v[24:27], v[16:19]
  v_mov_b32 v41, v39
  v_mov_b32 v43, v39
  s_lshr_b32 s56, s75, 2
  s_lshl_b32 s56, s56, 4
  s_and_b32 s58, s75, 3
  s_lshl_b32 s58, s58, 1
  s_add_u32 s56, s56, s58
  v_mov_b32 v40, v12
  v_mov_b32_dpp v40, v13 quad_perm:[0,1,2,3] row_mask:0xf bank_mask:0x2
  v_mov_b32_dpp v40, v14 quad_perm:[0,1,2,3] row_mask:0xf bank_mask:0x4
  v_mov_b32_dpp v40, v15 quad_perm:[0,1,2,3] row_mask:0xf bank_mask:0x8
  v_mov_b32 v42, v16
  v_mov_b32_dpp v42, v17 quad_perm:[0,1,2,3] row_mask:0xf bank_mask:0x2
  v_mov_b32_dpp v42, v18 quad_perm:[0,1,2,3] row_mask:0xf bank_mask:0x4
  v_mov_b32_dpp v42, v19 quad_perm:[0,1,2,3] row_mask:0xf bank_mask:0x8
  buffer_store_dwordx4 v[40:43], v50, s[36:39], s92 offen sc1
  s_and_b32 s58, s2, 3
  s_cmp_lg_u32 s58, 0
  s_cbranch_scc1 L_wavedone
  s_lshr_b32 s58, s2, 2
  s_lshl_b32 s55, s58, 12
  s_add_u32 s55, s55, 2097152
  s_lshl_b32 s56, s58, 4
  v_lshlrev_b32 v29, 1, v4
  s_mov_b32 s57, 20000
L_fpoll:
  buffer_load_dwordx4 v[64:67], v6, s[36:39], s55 offen offset:0 sc1
  buffer_load_dwordx4 v[68:71], v6, s[36:39], s55 offen offset:1024 sc1
  buffer_load_dwordx4 v[72:75], v6, s[36:39], s55 offen offset:2048 sc1
  buffer_load_dwordx4 v[76:79], v6, s[36:39], s55 offen offset:3072 sc1
  s_sub_u32 s57, s57, 1
  s_waitcnt vmcnt(0)
  v_min3_u32 v8, v65, v67, v39
  v_max3_u32 v9, v65, v67, v39
  v_add_f32 v12, v64, v68
  v_add_f32 v14, v66, v70
  v_min3_u32 v8, v8, v69, v71
  v_max3_u32 v9, v9, v69, v71
  v_min3_u32 v8, v8, v73, v75
  v_max3_u32 v9, v9, v73, v75
  v_min3_u32 v8, v8, v77, v79
  v_max3_u32 v9, v9, v77, v79
  v_add_f32 v13, v72, v76
  v_add_f32 v15, v74, v78
  v_cmp_ne_u32 vcc, v8, v9
  v_add_f32 v12, v12, v13
  v_add_f32 v14, v14, v15
  s_cmp_eq_u32 s57, 0
  s_cbranch_scc1 L_fdone
  s_cmp_eq_u64 vcc, 0
  s_cbranch_scc1 L_fdone
  s_sleep 1
  s_branch L_fpoll
L_fdone:
  v_add_f32_dpp v12, v12, v12 row_ror:4 row_mask:0xf bank_mask:0xf
  v_add_f32_dpp v14, v14, v14 row_ror:4 row_mask:0xf bank_mask:0xf
  s_nop 0
  v_add_f32_dpp v12, v12, v12 row_ror:8 row_mask:0xf bank_mask:0xf
  v_add_f32_dpp v14, v14, v14 row_ror:8 row_mask:0xf bank_mask:0xf
  s_nop 0
  v_mov_b32 v13, v12
  v_mov_b32 v15, v14
  s_nop 0
  v_permlane16_swap_b32 v12, v13
  v_permlane16_swap_b32 v14, v15
  s_nop 0
  v_add_f32 v12, v12, v13
  v_add_f32 v14, v14, v15
  v_mov_b32 v13, v12
  v_mov_b32 v15, v14
  s_nop 0
  v_permlane32_swap_b32 v12, v13
  v_permlane32_swap_b32 v14, v15
  s_nop 0
  v_add_f32 v12, v12, v13
  v_add_f32 v14, v14, v15
  v_cvt_pk_bf16_f32 v12, v12, v14
  s_mov_b64 exec, 15
  buffer_store_short v12, v29, s[40:43], s56 offen
  buffer_store_short_d16_hi v12, v29, s[40:43], s56 offen offset:8
  s_mov_b64 exec, 1
  s_cmp_lg_u32 s2, 0
  s_cbranch_scc1 L_noep
  buffer_store_dword v39, v29, s[36:39], 0 offen sc1
L_noep:
  s_mov_b64 exec, -1
L_wavedone:
L_end:
  s_endpgm
.section .rodata,"a"
.p2align 6
.amdhsa_kernel standalone__gqa_block_cached__decode_kernel
  .amdhsa_next_free_vgpr 208
  .amdhsa_next_free_sgpr 102
  .amdhsa_accum_offset 208
  .amdhsa_group_segment_fixed_size 0
  .amdhsa_kernarg_size 64
  .amdhsa_user_sgpr_count 2
  .amdhsa_user_sgpr_kernarg_segment_ptr 1
  .amdhsa_system_sgpr_workgroup_id_x 1
  .amdhsa_float_denorm_mode_32 3
.end_amdhsa_kernel
```
